```python
import torch

def _softmax(x, axis=-1):
    return torch.softmax(x, dim=axis)
def _gelu(x):
    return torch.nn.functional.gelu(x, approximate="tanh")
def _silu(x):
    return torch.nn.functional.silu(x)
def _sigmoid(x):
    return torch.sigmoid(x)
def _layernorm(x, axis=-1, eps=1e-5):
    m = x.mean(dim=axis, keepdim=True)
    v = x.var(dim=axis, keepdim=True, unbiased=False)
    return (x - m) / torch.sqrt(v + eps)
def _scatter_add(tgt, idx, src, axis=0):
    return tgt.clone().index_add_(axis, idx, src)
def _segment_sum(src, seg, n):
    out = torch.zeros((n,) + src.shape[1:], dtype=src.dtype)
    return out.index_add_(0, seg, src)
def _pad(x, pw):
    flat = tuple(v for pair in reversed(pw) for v in pair)
    return torch.nn.functional.pad(x, flat)

kernel_name = 'sequential_preLN__ssm_conv_s4__glu_gated_bilinear__prompt'

def setup_inputs():

    _w = (lambda a: (lambda t: t.to(torch.bfloat16) if t.is_floating_point() else t)(torch.as_tensor(a)))
    def _A_setup():
        B, L, D, N = 1, 2048, 576, 128
        A_re = -(lambda _x: torch.exp(torch.as_tensor(_x)))((lambda *s: torch.randn(*s, dtype=torch.bfloat16) * 3.2)(D, N))
        A_im = torch.pi * (lambda *s: torch.randn(*s, dtype=torch.bfloat16) * 0.05)(D, N)
        B_re = (lambda *s: torch.randn(*s, dtype=torch.bfloat16) * 0.1)(D, N)
        B_im = (lambda *s: torch.randn(*s, dtype=torch.bfloat16) * 0.1)(D, N)
        C_re = (lambda *s: torch.randn(*s, dtype=torch.bfloat16) * 0.1)(D, N)
        C_im = (lambda *s: torch.randn(*s, dtype=torch.bfloat16) * 0.1)(D, N)
        log_dt = (lambda *s: torch.randn(*s, dtype=torch.bfloat16) * 0.05)(D) * 0.5 - 4.0
        Dskip = (lambda *s: torch.randn(*s, dtype=torch.bfloat16) * 0.05)(D)
        return {
            "u": _w((lambda *s: torch.randn(*s, dtype=torch.bfloat16) * 0.05)(B, L, D)),
            "A_re": _w(A_re),
            "A_im": _w(A_im),
            "B_re": _w(B_re),
            "B_im": _w(B_im),
            "C_re": _w(C_re),
            "C_im": _w(C_im),
            "log_dt": _w(log_dt),
            "Dskip": _w(Dskip),
        }
    _A_in = _A_setup()

    def _B_setup():
        B, S, D, F = 1, 2048, 576, 4608
        return {
            "x": _w((lambda *s: torch.randn(*s, dtype=torch.bfloat16) * 0.05)(B, S, D)),
            "w_gate": _w((lambda *s: torch.randn(*s, dtype=torch.bfloat16) * 0.4)(D, F) * (D ** -0.5)),
            "w_up": _w((lambda *s: torch.randn(*s, dtype=torch.bfloat16) * 0.4)(D, F) * (D ** -0.5)),
            "w_down": _w((lambda *s: torch.randn(*s, dtype=torch.bfloat16) * 0.4)(F, D) * (F ** -0.5)),
        }
    _B_in = _B_setup()

    return {
        "A_u": _A_in["u"],
        "A_A_re": _A_in["A_re"],
        "A_A_im": _A_in["A_im"],
        "A_B_re": _A_in["B_re"],
        "A_B_im": _A_in["B_im"],
        "A_C_re": _A_in["C_re"],
        "A_C_im": _A_in["C_im"],
        "A_log_dt": _A_in["log_dt"],
        "A_Dskip": _A_in["Dskip"],
        "B_x": _B_in["x"],
        "B_w_gate": _B_in["w_gate"],
        "B_w_up": _B_in["w_up"],
        "B_w_down": _B_in["w_down"],
    }

def reference(A_u, A_A_re, A_A_im, A_B_re, A_B_im, A_C_re, A_C_im, A_log_dt, A_Dskip, B_x, B_w_gate, B_w_up, B_w_down):
    def _A_ref(u, A_re, A_im, B_re, B_im, C_re, C_im, log_dt, Dskip):
        Bsz, L, D = u.shape
        dt = torch.exp(log_dt)[:, None]
        A = A_re + 1j * A_im
        Bc = B_re + 1j * B_im
        Cc = C_re + 1j * C_im
        logdA = dt * A
        dB = dt * Bc
        l = (lambda x, dt: x.to(dt))(torch.arange(L), A_re.dtype)
        P = torch.exp(logdA[:, :, None] * l[None, None, :])
        K = torch.einsum("dn,dnl,dn->dl", Cc, P, dB).real
        L2 = 2 * L
        Kp = _pad(K, ((0, 0), (0, L)))
        up = (lambda x, *d: x.permute(*d))(u, 0, 2, 1)
        up = _pad(up, ((0, 0), (0, 0), (0, L)))
        Kf = (lambda x, axes=(-2,-1): torch.fft.rfft2(x.float(), dim=axes))(Kp[:, None, :], axes=(-2, -1))
        Uf = (lambda x, axes=(-2,-1): torch.fft.rfft2(x.float(), dim=axes))(up[:, :, None, :], axes=(-2, -1))
        Yf = Uf * Kf[None, :, :, :]
        y = (lambda x, s, axes=(-2,-1): torch.fft.irfft2(x, s=s, dim=axes).to(torch.bfloat16))(Yf, (1, L2), axes=(-2, -1))[:, :, 0, :L]
        y = (lambda x, *d: x.permute(*d))(y, 0, 2, 1) + u * Dskip[None, None, :]
        return y

    def _B_ref(x, w_gate, w_up, w_down):
        g = torch.einsum("bsd,df->bsf", x, w_gate)
        u = torch.einsum("bsd,df->bsf", x, w_up)
        h = g * u
        return torch.einsum("bsf,fd->bsd", h, w_down)

    x = A_u
    h = x + _A_ref(_layernorm(x, axis=-1), A_A_re, A_A_im, A_B_re, A_B_im, A_C_re, A_C_im, A_log_dt, A_Dskip)
    h2 = h + _B_ref(_layernorm(h, axis=-1), B_w_gate, B_w_up, B_w_down)
    return h2
```

```asm
; @launch grid=(256,1,1) block=(256,1,1) lds=163840
.amdgcn_target "amdgcn-amd-amdhsa--gfx950"
.text
.globl sequential_preLN__ssm_conv_s4__glu_gated_bilinear__prompt_kernel
.p2align 8
.type sequential_preLN__ssm_conv_s4__glu_gated_bilinear__prompt_kernel,@function
sequential_preLN__ssm_conv_s4__glu_gated_bilinear__prompt_kernel:

    s_cmp_ge_u32 s2, 256
    s_cbranch_scc1 KP_end
    s_load_dwordx16 s[36:51], s[0:1], 0
    s_load_dwordx2 s[52:53], s[0:1], 64
    s_load_dwordx4 s[8:11], s[0:1], 112
    s_load_dwordx4 s[12:15], s[0:1], 80
    v_lshrrev_b32 v2, 6, v0
    v_and_b32 v1, 63, v0
    s_lshr_b32 s16, s2, 3
    s_getpc_b64 s[80:81]
    s_and_b32 s80, s80, 0xfffff000
    s_mul_i32 s7, s16, 12
    v_min_u32 v3, 2, v1
    v_mad_u32_u24 v3, v2, 3, v3
    v_add_u32 v3, s7, v3
    v_min_u32 v3, 351, v3
    v_lshlrev_b32 v4, 7, v3
    v_mov_b32 v5, s81
    v_add_co_u32 v4, vcc, s80, v4
    s_nop 1
    v_addc_co_u32 v5, vcc, 0, v5, vcc
    global_load_dword v219, v[4:5], off
    v_readfirstlane_b32 s6, v2
    s_bfe_u32 s17, s2, 0x20001
    s_and_b32 s18, s2, 1
    s_mul_i32 s19, s16, 37
    s_lshr_b32 s19, s19, 8
    s_mul_i32 s64, s19, 7
    s_sub_u32 s64, s16, s64
    s_mul_i32 s63, s18, 5
    s_add_u32 s63, s63, s19
    s_lshl_b32 s7, s18, 2
    s_add_u32 s7, s7, s64
    s_lshl_b32 s7, s7, 2
    s_lshr_b32 s30, 0x06524310, s7
    s_and_b32 s30, s30, 7
    s_lshr_b32 s29, 0x14304310, s7
    s_and_b32 s29, s29, 7
    s_cmp_ge_u32 s16, 28
    s_cselect_b32 s29, s29, s64
    s_cselect_b32 s64, s30, s64
    s_cselect_b32 s63, 4, s63
    s_mul_i32 s7, s17, 9
    s_add_u32 s63, s63, s7
    s_lshl_b32 s28, s18, 2
    s_add_u32 s28, s28, s7
    s_lshl_b32 s28, s28, 8
    s_mul_i32 s62, s63, 7
    s_add_u32 s62, s62, s64
    s_mul_i32 s65, s63, 3
    s_add_u32 s65, s65, s64
    s_add_u32 s7, s65, s63
    s_sub_u32 s7, s7, 3
    s_mul_i32 s30, s19, 3
    s_add_u32 s29, s29, s30
    s_add_u32 s30, s29, s19
    s_sub_u32 s30, s30, 3
    s_lshl_b32 s29, s19, 1
    s_add_u32 s29, s29, s64
    s_lshl_b32 s66, s18, 1
    s_sub_u32 s66, s19, s66
    s_add_u32 s66, s66, 10
    s_cmp_eq_u32 s64, 2
    s_cselect_b32 s29, s66, s29
    s_cmp_eq_u32 s16, 31
    s_cselect_b32 s29, 13, s29
    s_lshl_b32 s65, s29, 3
    s_and_b32 s66, s2, 7
    s_add_u32 s65, s65, s66
    s_cmp_ge_u32 s64, 3
    s_cselect_b32 s3, 1, 0
    s_cselect_b32 s65, s7, s65
    s_cselect_b32 s29, s30, s29
    s_cbranch_scc1 KP_e1
    s_cmp_lt_u32 s65, 64
    s_cselect_b32 s3, 3, 0
    s_and_b32 s7, s2, 0xf9
    s_cmp_eq_u32 s7, 0xf9
    s_cbranch_scc0 KP_e1
    s_mov_b32 s3, 2
    s_add_u32 s62, s17, 252
KP_e1:
    s_lshl_b32 s67, s63, 8
    s_and_b32 s7, s6, 1
    s_lshl_b32 s7, s7, 7
    s_add_u32 s67, s67, s7
    s_lshl_b32 s31, s6, 13
    v_lshrrev_b32 v2, 4, v0
    v_and_b32 v3, 15, v0
    v_lshlrev_b32 v3, 3, v3
    s_movk_i32 s7, 1152
    v_mad_u32_u24 v22, v2, s7, v3
    s_mul_i32 s33, s65, 18432
    s_lshl_b32 s34, s65, 2
    s_add_u32 s34, s34, s6
    s_sub_u32 s34, s34, 256
    s_cmp_lt_u32 s34, 114
    s_cselect_b32 s7, 0, 2.0
    s_lshl_b32 s34, s34, 10
    s_add_u32 s34, s34, 47775744
    v_lshl_add_u32 v66, v1, 4, s7
    v_mov_b64 v[68:69], 0
    v_mov_b64 v[70:71], 0
    s_lshl_b32 s7, s65, 10
    v_lshl_add_u32 v4, v0, 2, s7
    s_lshl_b32 s7, s65, 3
    s_cmp_eq_u32 s3, 1
    s_waitcnt lgkmcnt(0)
    s_cbranch_scc0 KP_e2
    s_load_dwordx2 s[76:77], s[50:51], s7
    s_load_dwordx2 s[78:79], s[52:53], s7
    global_load_dword v70, v4, s[38:39] nt
    global_load_dword v71, v4, s[40:41] nt
    global_load_dword v72, v4, s[42:43] nt
    global_load_dword v73, v4, s[44:45] nt
    global_load_dword v74, v4, s[46:47] nt
    global_load_dword v75, v4, s[48:49] nt
    s_cmp_eq_u32 s6, 1
    s_cbranch_scc0 TR_1
    s_call_b64 s[82:83], PG_3
TR_1:
    s_cmp_eq_u32 s6, 2
    s_cbranch_scc0 TR_2
    s_call_b64 s[82:83], PG_10
TR_2:
    s_cmp_eq_u32 s6, 3
    s_cbranch_scc0 TR_3
    s_call_b64 s[82:83], PG_4
TR_3:
    s_branch PG_2_go
KP_e2:
    s_cmp_lt_u32 s6, 2
    s_cselect_b32 s24, s12, s14
    s_cselect_b32 s25, s13, s15
    s_mov_b32 s26, 5308416
    s_mov_b32 s27, 0x00020000
    s_mov_b64 s[4:5], s[10:11]
    s_mov_b64 s[20:21], s[10:11]
    s_mov_b32 s22, 0x10000000
    s_mov_b32 s23, 0x00020000
    s_mov_b64 s[68:69], s[8:9]
    s_movk_i32 s70, 256
    s_mov_b32 s71, 0x00020000
    s_mov_b32 s38, 2359296
    s_mov_b32 s39, 0x00020000
    s_lshr_b32 s35, s65, 5
    s_cmp_lg_u32 s35, 2
    s_cbranch_scc1 KP_x0
    buffer_store_dwordx4 v[68:71], v66, s[20:23], s34 offen sc1
KP_x0:
    buffer_load_dwordx2 v[4:5], v22, s[36:39], s33 offen offset:0
    buffer_load_dwordx2 v[6:7], v22, s[36:39], s33 offen offset:128
    buffer_load_dwordx2 v[8:9], v22, s[36:39], s33 offen offset:256
    buffer_load_dwordx2 v[10:11], v22, s[36:39], s33 offen offset:384
    buffer_load_dwordx2 v[12:13], v22, s[36:39], s33 offen offset:512
    buffer_load_dwordx2 v[14:15], v22, s[36:39], s33 offen offset:640
    buffer_load_dwordx2 v[16:17], v22, s[36:39], s33 offen offset:768
    buffer_load_dwordx2 v[18:19], v22, s[36:39], s33 offen offset:896
    buffer_load_dwordx2 v[20:21], v22, s[36:39], s33 offen offset:1024
    s_add_u32 s33, s33, 294912
    s_cmp_ge_u32 s65, 96
    s_cselect_b32 s66, 2, 1
    s_cbranch_scc0 KP_x1
    buffer_load_dwordx2 v[80:81], v22, s[36:39], s33 offen offset:0
    buffer_load_dwordx2 v[82:83], v22, s[36:39], s33 offen offset:128
    buffer_load_dwordx2 v[84:85], v22, s[36:39], s33 offen offset:256
    buffer_load_dwordx2 v[86:87], v22, s[36:39], s33 offen offset:384
    buffer_load_dwordx2 v[88:89], v22, s[36:39], s33 offen offset:512
    buffer_load_dwordx2 v[90:91], v22, s[36:39], s33 offen offset:640
    buffer_load_dwordx2 v[92:93], v22, s[36:39], s33 offen offset:768
    buffer_load_dwordx2 v[94:95], v22, s[36:39], s33 offen offset:896
    buffer_load_dwordx2 v[96:97], v22, s[36:39], s33 offen offset:1024
KP_x1:
    s_movk_i32 s10, 1184
    v_mad_u32_u24 v23, v2, s10, v3
    v_lshrrev_b32 v2, 3, v2
    v_lshl_add_u32 v23, v2, 7, v23
    v_add_u32 v23, 19200, v23
    v_and_b32 v2, 1, v1
    v_bfe_u32 v3, v1, 2, 2
    v_lshl_add_u32 v3, v2, 3, v3
    v_mul_u32_u24 v64, s10, v3
    v_lshl_add_u32 v64, v2, 7, v64
    v_lshrrev_b32 v2, 4, v1
    v_bfe_u32 v3, v1, 1, 1
    v_lshl_add_u32 v3, v2, 1, v3
    v_lshl_add_u32 v64, v3, 3, v64
    s_mul_i32 s13, s6, 9
    s_lshr_b32 s13, s13, 1
    s_lshl_b32 s14, s13, 6
    s_add_u32 s14, s14, 19200
    v_add_u32 v64, s14, v64
    v_lshrrev_b32 v2, 3, v1
    v_mul_u32_u24 v65, 16512, v2
    v_bfe_u32 v2, v1, 2, 1
    v_lshl_add_u32 v65, v2, 6, v65
    s_lshr_b32 s14, s65, 1
    v_xor_b32 v2, s14, v1
    v_and_b32 v2, 3, v2
    v_lshl_add_u32 v65, v2, 4, v65
    s_mul_i32 s16, s13, 132096
    s_lshl_b32 s15, s65, 7
    s_add_u32 s16, s16, s15
    s_lshl_b32 s7, s65, 7
    s_add_u32 s7, s7, 47878144
    v_mov_b32 v72, s7
    v_cmp_eq_u32 vcc, 0, v0
    v_mov_b32 v73, -1
    s_nop 0
    v_cndmask_b32 v72, 2.0, v72, vcc
    s_and_b32 s17, s65, 3
    s_lshl_b32 s17, s17, 6
    v_lshlrev_b32 v66, 8, v0
    v_mov_b32 v67, 1
    s_cmp_eq_u32 s3, 3
    s_cbranch_scc1 KP_l1
    s_waitcnt vmcnt(9)
    s_cmp_eq_u32 s35, 3
    s_cbranch_scc1 KP_l0
    s_barrier
    buffer_atomic_add v67, v66, s[68:71], s17 offen sc1
    s_waitcnt vmcnt(1)
KP_l0:
KP_l1:
    s_cmp_eq_u32 s3, 3
    s_cbranch_scc0 KP_lw0
    s_waitcnt vmcnt(6)
KP_lw0:
    v_lshlrev_b32 v24, 16, v4
    v_and_b32 v25, 0xffff0000, v4
    v_pk_mul_f32 v[62:63], v[24:25], v[24:25]
    v_lshlrev_b32 v26, 16, v5
    v_and_b32 v27, 0xffff0000, v5
    v_pk_add_f32 v[60:61], v[24:25], v[26:27]
    v_pk_fma_f32 v[62:63], v[26:27], v[26:27], v[62:63]
    v_lshlrev_b32 v28, 16, v6
    v_and_b32 v29, 0xffff0000, v6
    v_pk_add_f32 v[60:61], v[60:61], v[28:29]
    v_pk_fma_f32 v[62:63], v[28:29], v[28:29], v[62:63]
    v_lshlrev_b32 v30, 16, v7
    v_and_b32 v31, 0xffff0000, v7
    v_pk_add_f32 v[60:61], v[60:61], v[30:31]
    v_pk_fma_f32 v[62:63], v[30:31], v[30:31], v[62:63]
    v_lshlrev_b32 v32, 16, v8
    v_and_b32 v33, 0xffff0000, v8
    v_pk_add_f32 v[60:61], v[60:61], v[32:33]
    v_pk_fma_f32 v[62:63], v[32:33], v[32:33], v[62:63]
    v_lshlrev_b32 v34, 16, v9
    v_and_b32 v35, 0xffff0000, v9
    v_pk_add_f32 v[60:61], v[60:61], v[34:35]
    v_pk_fma_f32 v[62:63], v[34:35], v[34:35], v[62:63]
    s_cbranch_scc0 KP_lw3
    s_waitcnt vmcnt(3)
KP_lw3:
    v_lshlrev_b32 v36, 16, v10
    v_and_b32 v37, 0xffff0000, v10
    v_pk_add_f32 v[60:61], v[60:61], v[36:37]
    v_pk_fma_f32 v[62:63], v[36:37], v[36:37], v[62:63]
    v_lshlrev_b32 v38, 16, v11
    v_and_b32 v39, 0xffff0000, v11
    v_pk_add_f32 v[60:61], v[60:61], v[38:39]
    v_pk_fma_f32 v[62:63], v[38:39], v[38:39], v[62:63]
    v_lshlrev_b32 v40, 16, v12
    v_and_b32 v41, 0xffff0000, v12
    v_pk_add_f32 v[60:61], v[60:61], v[40:41]
    v_pk_fma_f32 v[62:63], v[40:41], v[40:41], v[62:63]
    v_lshlrev_b32 v42, 16, v13
    v_and_b32 v43, 0xffff0000, v13
    v_pk_add_f32 v[60:61], v[60:61], v[42:43]
    v_pk_fma_f32 v[62:63], v[42:43], v[42:43], v[62:63]
    v_lshlrev_b32 v44, 16, v14
    v_and_b32 v45, 0xffff0000, v14
    v_pk_add_f32 v[60:61], v[60:61], v[44:45]
    v_pk_fma_f32 v[62:63], v[44:45], v[44:45], v[62:63]
    v_lshlrev_b32 v46, 16, v15
    v_and_b32 v47, 0xffff0000, v15
    v_pk_add_f32 v[60:61], v[60:61], v[46:47]
    v_pk_fma_f32 v[62:63], v[46:47], v[46:47], v[62:63]
    s_cbranch_scc0 KP_lw6
    s_waitcnt vmcnt(0)
KP_lw6:
    v_lshlrev_b32 v48, 16, v16
    v_and_b32 v49, 0xffff0000, v16
    v_pk_add_f32 v[60:61], v[60:61], v[48:49]
    v_pk_fma_f32 v[62:63], v[48:49], v[48:49], v[62:63]
    v_lshlrev_b32 v50, 16, v17
    v_and_b32 v51, 0xffff0000, v17
    v_pk_add_f32 v[60:61], v[60:61], v[50:51]
    v_pk_fma_f32 v[62:63], v[50:51], v[50:51], v[62:63]
    v_lshlrev_b32 v52, 16, v18
    v_and_b32 v53, 0xffff0000, v18
    v_pk_add_f32 v[60:61], v[60:61], v[52:53]
    v_pk_fma_f32 v[62:63], v[52:53], v[52:53], v[62:63]
    v_lshlrev_b32 v54, 16, v19
    v_and_b32 v55, 0xffff0000, v19
    v_pk_add_f32 v[60:61], v[60:61], v[54:55]
    v_pk_fma_f32 v[62:63], v[54:55], v[54:55], v[62:63]
    v_lshlrev_b32 v56, 16, v20
    v_and_b32 v57, 0xffff0000, v20
    v_pk_add_f32 v[60:61], v[60:61], v[56:57]
    v_pk_fma_f32 v[62:63], v[56:57], v[56:57], v[62:63]
    v_lshlrev_b32 v58, 16, v21
    v_and_b32 v59, 0xffff0000, v21
    v_pk_add_f32 v[60:61], v[60:61], v[58:59]
    v_pk_fma_f32 v[62:63], v[58:59], v[58:59], v[62:63]
    v_add_f32 v60, v60, v61
    v_add_f32 v62, v62, v63
    s_nop 0
    v_add_f32 v60, v60, v60 row_ror:8 row_mask:0xf bank_mask:0xf
    v_add_f32 v62, v62, v62 row_ror:8 row_mask:0xf bank_mask:0xf
    s_nop 0
    v_add_f32 v60, v60, v60 row_ror:4 row_mask:0xf bank_mask:0xf
    v_add_f32 v62, v62, v62 row_ror:4 row_mask:0xf bank_mask:0xf
    s_nop 0
    v_add_f32 v60, v60, v60 row_ror:2 row_mask:0xf bank_mask:0xf
    v_add_f32 v62, v62, v62 row_ror:2 row_mask:0xf bank_mask:0xf
    s_nop 0
    v_add_f32 v60, v60, v60 row_ror:1 row_mask:0xf bank_mask:0xf
    v_add_f32 v62, v62, v62 row_ror:1 row_mask:0xf bank_mask:0xf
    s_nop 0
    v_mul_f32 v60, 0x3ae38e39, v60
    v_mul_f32 v61, v60, v60
    v_mul_f32 v62, 0x3ae38e39, v62
    v_sub_f32 v62, v62, v61
    v_max_f32 v62, 0, v62
    v_cvt_pk_bf16_f32 v62, v62, v62
    v_and_b32 v62, 0xffff0000, v62
    v_add_f32 v62, 0x3727c5ac, v62
    v_cvt_pk_bf16_f32 v62, v62, v62
    v_and_b32 v62, 0xffff0000, v62
    v_sqrt_f32 v62, v62
    v_cvt_pk_bf16_f32 v60, v60, v60
    v_and_b32 v60, 0xffff0000, v60
    v_cvt_pk_bf16_f32 v62, v62, v62
    v_and_b32 v62, 0xffff0000, v62
    v_rcp_f32 v62, v62
    s_nop 0
    v_mul_f32 v60, v60, v62
    v_pk_fma_f32 v[24:25], v[24:25], v[62:63], v[60:61] op_sel_hi:[1,0,0] neg_lo:[0,0,1] neg_hi:[0,0,1]
    v_pk_fma_f32 v[26:27], v[26:27], v[62:63], v[60:61] op_sel_hi:[1,0,0] neg_lo:[0,0,1] neg_hi:[0,0,1]
    v_cvt_pk_bf16_f32 v24, v24, v25
    v_cvt_pk_bf16_f32 v25, v26, v27
    ds_write_b64 v23, v[24:25] offset:0
    v_pk_fma_f32 v[28:29], v[28:29], v[62:63], v[60:61] op_sel_hi:[1,0,0] neg_lo:[0,0,1] neg_hi:[0,0,1]
    v_pk_fma_f32 v[30:31], v[30:31], v[62:63], v[60:61] op_sel_hi:[1,0,0] neg_lo:[0,0,1] neg_hi:[0,0,1]
    v_cvt_pk_bf16_f32 v28, v28, v29
    v_cvt_pk_bf16_f32 v29, v30, v31
    ds_write_b64 v23, v[28:29] offset:128
    v_pk_fma_f32 v[32:33], v[32:33], v[62:63], v[60:61] op_sel_hi:[1,0,0] neg_lo:[0,0,1] neg_hi:[0,0,1]
    v_pk_fma_f32 v[34:35], v[34:35], v[62:63], v[60:61] op_sel_hi:[1,0,0] neg_lo:[0,0,1] neg_hi:[0,0,1]
    v_cvt_pk_bf16_f32 v32, v32, v33
    v_cvt_pk_bf16_f32 v33, v34, v35
    ds_write_b64 v23, v[32:33] offset:256
    v_pk_fma_f32 v[36:37], v[36:37], v[62:63], v[60:61] op_sel_hi:[1,0,0] neg_lo:[0,0,1] neg_hi:[0,0,1]
    v_pk_fma_f32 v[38:39], v[38:39], v[62:63], v[60:61] op_sel_hi:[1,0,0] neg_lo:[0,0,1] neg_hi:[0,0,1]
    v_cvt_pk_bf16_f32 v36, v36, v37
    v_cvt_pk_bf16_f32 v37, v38, v39
    ds_write_b64 v23, v[36:37] offset:384
    v_pk_fma_f32 v[40:41], v[40:41], v[62:63], v[60:61] op_sel_hi:[1,0,0] neg_lo:[0,0,1] neg_hi:[0,0,1]
    v_pk_fma_f32 v[42:43], v[42:43], v[62:63], v[60:61] op_sel_hi:[1,0,0] neg_lo:[0,0,1] neg_hi:[0,0,1]
    v_cvt_pk_bf16_f32 v40, v40, v41
    v_cvt_pk_bf16_f32 v41, v42, v43
    ds_write_b64 v23, v[40:41] offset:512
    v_pk_fma_f32 v[44:45], v[44:45], v[62:63], v[60:61] op_sel_hi:[1,0,0] neg_lo:[0,0,1] neg_hi:[0,0,1]
    v_pk_fma_f32 v[46:47], v[46:47], v[62:63], v[60:61] op_sel_hi:[1,0,0] neg_lo:[0,0,1] neg_hi:[0,0,1]
    v_cvt_pk_bf16_f32 v44, v44, v45
    v_cvt_pk_bf16_f32 v45, v46, v47
    ds_write_b64 v23, v[44:45] offset:640
    v_pk_fma_f32 v[48:49], v[48:49], v[62:63], v[60:61] op_sel_hi:[1,0,0] neg_lo:[0,0,1] neg_hi:[0,0,1]
    v_pk_fma_f32 v[50:51], v[50:51], v[62:63], v[60:61] op_sel_hi:[1,0,0] neg_lo:[0,0,1] neg_hi:[0,0,1]
    v_cvt_pk_bf16_f32 v48, v48, v49
    v_cvt_pk_bf16_f32 v49, v50, v51
    ds_write_b64 v23, v[48:49] offset:768
    v_pk_fma_f32 v[52:53], v[52:53], v[62:63], v[60:61] op_sel_hi:[1,0,0] neg_lo:[0,0,1] neg_hi:[0,0,1]
    v_pk_fma_f32 v[54:55], v[54:55], v[62:63], v[60:61] op_sel_hi:[1,0,0] neg_lo:[0,0,1] neg_hi:[0,0,1]
    v_cvt_pk_bf16_f32 v52, v52, v53
    v_cvt_pk_bf16_f32 v53, v54, v55
    ds_write_b64 v23, v[52:53] offset:896
    v_pk_fma_f32 v[56:57], v[56:57], v[62:63], v[60:61] op_sel_hi:[1,0,0] neg_lo:[0,0,1] neg_hi:[0,0,1]
    v_pk_fma_f32 v[58:59], v[58:59], v[62:63], v[60:61] op_sel_hi:[1,0,0] neg_lo:[0,0,1] neg_hi:[0,0,1]
    v_cvt_pk_bf16_f32 v56, v56, v57
    v_cvt_pk_bf16_f32 v57, v58, v59
    ds_write_b64 v23, v[56:57] offset:1024
    s_waitcnt lgkmcnt(0)
    s_barrier
    ds_read_b64_tr_b16 v[100:101], v64 offset:0
    ds_read_b64_tr_b16 v[102:103], v64 offset:4736
    ds_read_b64_tr_b16 v[104:105], v64 offset:64
    ds_read_b64_tr_b16 v[106:107], v64 offset:4800
    ds_read_b64_tr_b16 v[108:109], v64 offset:128
    ds_read_b64_tr_b16 v[110:111], v64 offset:4864
    ds_read_b64_tr_b16 v[112:113], v64 offset:192
    ds_read_b64_tr_b16 v[114:115], v64 offset:4928
    ds_read_b64_tr_b16 v[116:117], v64 offset:256
    ds_read_b64_tr_b16 v[118:119], v64 offset:4992
    s_waitcnt lgkmcnt(8)
    buffer_store_dwordx4 v[100:103], v65, s[20:23], s16 offen sc1
    s_add_u32 s16, s16, 132096
    s_waitcnt lgkmcnt(6)
    buffer_store_dwordx4 v[104:107], v65, s[20:23], s16 offen sc1
    s_add_u32 s16, s16, 132096
    s_waitcnt lgkmcnt(4)
    buffer_store_dwordx4 v[108:111], v65, s[20:23], s16 offen sc1
    s_add_u32 s16, s16, 132096
    s_waitcnt lgkmcnt(2)
    buffer_store_dwordx4 v[112:115], v65, s[20:23], s16 offen sc1
    s_add_u32 s16, s16, 132096
    s_waitcnt lgkmcnt(0)
    buffer_store_dwordx4 v[116:119], v65, s[20:23], s16 offen sc1
    s_add_u32 s16, s16, 132096
    v_add_u32 v24, 125440, v23
    ds_write_b64 v24, v[4:5] offset:0
    ds_write_b64 v24, v[6:7] offset:128
    ds_write_b64 v24, v[8:9] offset:256
    ds_write_b64 v24, v[10:11] offset:384
    ds_write_b64 v24, v[12:13] offset:512
    ds_write_b64 v24, v[14:15] offset:640
    ds_write_b64 v24, v[16:17] offset:768
    ds_write_b64 v24, v[18:19] offset:896
    ds_write_b64 v24, v[20:21] offset:1024
    s_sub_u32 s66, s66, 1
    s_cmp_eq_u32 s66, 0
    s_cbranch_scc1 KP_l3
    s_waitcnt vmcnt(5)
    v_mov_b64 v[4:5], v[80:81]
    v_mov_b64 v[6:7], v[82:83]
    v_mov_b64 v[8:9], v[84:85]
    v_mov_b64 v[10:11], v[86:87]
    v_mov_b64 v[12:13], v[88:89]
    v_mov_b64 v[14:15], v[90:91]
    v_mov_b64 v[16:17], v[92:93]
    v_mov_b64 v[18:19], v[94:95]
    v_mov_b64 v[20:21], v[96:97]
    v_add_u32 v23, -19200, v23
    v_add_u32 v64, -19200, v64
    s_sub_u32 s16, s16, 658432
    s_branch KP_l1
KP_l3:
    v_and_b32 v23, 3, v1
    v_lshlrev_b32 v23, 6, v23
    s_cmp_eq_u32 s6, 0
    s_cselect_b32 s70, 256, 0
    buffer_load_dword v22, v23, s[68:71], 0 offen sc1
    v_lshrrev_b32 v2, 3, v1
    v_mul_u32_u24 v212, 9216, v2
    v_lshrrev_b32 v2, 4, v1
    v_lshrrev_b32 v3, 1, v1
    v_xor_b32 v2, v2, v3
    v_and_b32 v2, 3, v2
    v_lshl_add_u32 v212, v2, 5, v212
    v_and_b32 v2, 1, v1
    v_lshl_add_u32 v212, v2, 4, v212
    v_add_u32 v213, 72704, v212
    v_add_u32 v214, 145408, v212
    v_add_u32 v215, 218112, v212
    v_lshrrev_b32 v2, 2, v1
    v_lshlrev_b32 v208, 7, v2
    v_and_b32 v3, 3, v1
    v_lshl_add_u32 v208, v3, 3, v208
    s_lshr_b32 s30, s6, 1
    s_lshl_b32 s30, s30, 13
    v_add_u32 v208, s30, v208
    v_bfe_u32 v2, v1, 3, 2
    s_and_b32 s30, s6, 1
    s_lshl_b32 s30, s30, 1
    v_xor_b32 v2, s30, v2
    v_lshl_add_u32 v208, v2, 5, v208
    v_xor_b32 v209, 32, v208
    v_add_u32 v210, 65536, v208
    v_add_u32 v211, 65536, v209
    s_mov_b32 s66, 0
    s_waitcnt vmcnt(0) lgkmcnt(0)
    s_cmp_lg_u32 s6, 0
    s_cbranch_scc1 KP_r1_x
    v_cmp_gt_u32 vcc, 8, v22
    s_cbranch_vccz KP_r1_x
    s_mov_b32 s61, 1048576
KP_r1:
    s_sleep 8
KP_r1_f:
    buffer_load_dword v22, v23, s[68:71], 0 offen sc1
    s_sub_u32 s61, s61, 1
    s_cbranch_scc1 KP_r1_x
    s_waitcnt vmcnt(0)
    v_cmp_gt_u32 vcc, 8, v22
    s_cbranch_vccnz KP_r1
KP_r1_x:
    s_barrier
    buffer_store_dword v67, v72, s[20:23], 0 offen sc1
    s_lshl_b32 s7, s29, 1
    s_and_b32 s8, s6, 1
    s_add_u32 s7, s7, s8
    s_add_u32 s7, s7, 36
    s_lshl_b32 s7, s7, 6
    v_add_u32 v216, s7, v1
    v_mul_u32_u24 v217, 52429, v216
    v_lshrrev_b32 v217, 19, v217
    v_mul_u32_u24 v217, 7936, v217
    v_lshl_add_u32 v217, v216, 7, v217
    buffer_load_dword v218, v217, s[24:27], s28 offen
    v_add_u32 v216, 1792, v216
    v_mul_u32_u24 v217, 52429, v216
    v_lshrrev_b32 v217, 19, v217
    v_mul_u32_u24 v217, 7936, v217
    v_lshl_add_u32 v217, v216, 7, v217
    buffer_load_dword v218, v217, s[24:27], s28 offen
    s_cmp_eq_u32 s6, 0
    s_cbranch_scc0 TR_4
    s_call_b64 s[82:83], PG_9
    s_call_b64 s[82:83], PG_bodyA
TR_4:
    s_cmp_eq_u32 s6, 1
    s_cbranch_scc0 TR_5
    s_call_b64 s[82:83], PG_4
    s_call_b64 s[82:83], PG_6
TR_5:
    s_cmp_eq_u32 s6, 2
    s_cbranch_scc0 TR_6
    s_call_b64 s[82:83], PG_5
    s_call_b64 s[82:83], PG_7
TR_6:
    s_cmp_eq_u32 s6, 3
    s_cbranch_scc0 TR_7
    s_call_b64 s[82:83], PG_8
    s_call_b64 s[82:83], PG_bodyB
TR_7:
    s_branch PG_1_go
PG_1_prev_end:
    .p2align 12
PG_1:
    s_setpc_b64 s[82:83]
PG_1_go:

    s_mov_b32 s7, 47808512
    s_cmp_eq_u32 s3, 3
    s_cselect_b32 s7, 47826944, s7
    v_lshl_add_u32 v149, v1, 7, s7
    v_add_u32 v150, 8192, v149
    v_min_u32 v151, 15, v1
    s_add_u32 s7, s7, 16384
    v_lshl_add_u32 v151, v151, 7, s7
    s_and_b32 s9, s6, 1
    s_lshr_b32 s13, s6, 1
    s_mul_i32 s10, s6, 9
    s_lshr_b32 s10, s10, 1
    s_mul_i32 s11, s9, 9
    s_lshl1_add_u32 s78, s9, 1
    s_cmp_ge_u32 s65, 96
    s_cselect_b32 s10, s11, s10
    s_cselect_b32 s78, 0, s78
    s_cselect_b32 s9, s9, s13
    s_cselect_b32 s13, s13, 0
    s_lshl4_add_u32 s8, s13, s65
    s_lshl_b32 s12, s10, 6
    s_mul_i32 s13, s13, 19200
    s_sub_u32 s12, s12, s13
    s_add_u32 s12, s12, 144640
    v_and_b32 v2, 15, v1
    v_lshrrev_b32 v3, 4, v1
    v_mul_u32_u24 v138, 16512, v3
    v_lshl_add_u32 v138, v2, 3, v138
    v_lshlrev_b32 v139, 4, v1
    s_lshl_b32 s80, s8, 7
    s_mul_i32 s13, s10, 132096
    s_add_u32 s80, s80, s13
    s_add_u32 s80, s80, 4718592
    s_mul_i32 s13, s8, 9363
    s_lshr_b32 s13, s13, 16
    s_mul_i32 s14, s13, 7
    s_sub_u32 s14, s8, s14
    s_min_u32 s15, s14, 2
    s_mul_i32 s16, s14, 18
    s_add_u32 s16, s16, s15
    s_cmp_lt_u32 s14, 2
    s_cselect_b32 s15, 18, 17
    s_lshr_b32 s14, s13, 1
    s_sub_u32 s15, s15, s14
    s_bitcmp1_b32 s13, 0
    s_cselect_b32 s14, s15, s14
    s_add_u32 s16, s16, s14
    s_mul_i32 s81, s16, 18
    s_add_u32 s81, s81, s10
    s_lshl_b32 s81, s81, 10
    s_add_u32 s81, s81, 11796480
    s_lshl1_add_u32 s16, s16, s9
    s_lshl_b32 s13, s6, 7
    s_add_u32 s13, s13, 98304
    v_lshl_add_u32 v136, v2, 3, s13
    v_xor_b32 v137, 128, v136
    v_xor_b32 v146, 256, v136
    v_xor_b32 v147, 384, v136
    s_lshl_b32 s7, s16, 7
    s_add_u32 s7, s7, 47845376
    v_mov_b32 v148, s7
    v_cmp_eq_u32 vcc, 0, v1
    v_mov_b32 v60, -1
    s_nop 0
    v_cndmask_b32 v148, 2.0, v148, vcc
    s_cmp_eq_u32 s78, 3
    s_cselect_b32 s7, 2.0, 0
    v_or_b32 v148, s7, v148
    v_mul_u32_u24 v19, 1184, v2
    v_lshrrev_b32 v2, 3, v2
    v_lshl_add_u32 v19, v2, 7, v19
    v_lshl_add_u32 v19, v3, 3, v19
    v_add_u32 v19, s12, v19
    ds_read2_b64 v[24:27], v19 offset0:0 offset1:4
    ds_read2_b64 v[28:31], v19 offset0:8 offset1:12
    ds_read2_b64 v[32:35], v19 offset0:16 offset1:20
    ds_read2_b64 v[36:39], v19 offset0:24 offset1:28
    ds_read2_b64 v[40:43], v19 offset0:32 offset1:36
    ds_read2_b64 v[44:47], v19 offset0:40 offset1:44
    ds_read2_b64 v[48:51], v19 offset0:48 offset1:52
    ds_read2_b64 v[52:55], v19 offset0:56 offset1:60
    ds_read2_b64 v[56:59], v19 offset0:64 offset1:68
    s_waitcnt lgkmcnt(0)
    v_lshlrev_b32 v64, 16, v24
    v_and_b32 v65, 0xffff0000, v24
    v_lshlrev_b32 v66, 16, v25
    v_and_b32 v67, 0xffff0000, v25
    v_lshlrev_b32 v68, 16, v26
    v_and_b32 v69, 0xffff0000, v26
    v_lshlrev_b32 v70, 16, v27
    v_and_b32 v71, 0xffff0000, v27
    v_lshlrev_b32 v72, 16, v28
    v_and_b32 v73, 0xffff0000, v28
    v_lshlrev_b32 v74, 16, v29
    v_and_b32 v75, 0xffff0000, v29
    v_lshlrev_b32 v76, 16, v30
    v_and_b32 v77, 0xffff0000, v30
    v_lshlrev_b32 v78, 16, v31
    v_and_b32 v79, 0xffff0000, v31
    v_lshlrev_b32 v80, 16, v32
    v_and_b32 v81, 0xffff0000, v32
    v_lshlrev_b32 v82, 16, v33
    v_and_b32 v83, 0xffff0000, v33
    v_lshlrev_b32 v84, 16, v34
    v_and_b32 v85, 0xffff0000, v34
    v_lshlrev_b32 v86, 16, v35
    v_and_b32 v87, 0xffff0000, v35
    v_lshlrev_b32 v88, 16, v36
    v_and_b32 v89, 0xffff0000, v36
    v_lshlrev_b32 v90, 16, v37
    v_and_b32 v91, 0xffff0000, v37
    v_lshlrev_b32 v92, 16, v38
    v_and_b32 v93, 0xffff0000, v38
    v_lshlrev_b32 v94, 16, v39
    v_and_b32 v95, 0xffff0000, v39
    v_lshlrev_b32 v96, 16, v40
    v_and_b32 v97, 0xffff0000, v40
    v_lshlrev_b32 v98, 16, v41
    v_and_b32 v99, 0xffff0000, v41
    v_lshlrev_b32 v100, 16, v42
    v_and_b32 v101, 0xffff0000, v42
    v_lshlrev_b32 v102, 16, v43
    v_and_b32 v103, 0xffff0000, v43
    v_lshlrev_b32 v104, 16, v44
    v_and_b32 v105, 0xffff0000, v44
    v_lshlrev_b32 v106, 16, v45
    v_and_b32 v107, 0xffff0000, v45
    v_lshlrev_b32 v108, 16, v46
    v_and_b32 v109, 0xffff0000, v46
    v_lshlrev_b32 v110, 16, v47
    v_and_b32 v111, 0xffff0000, v47
    v_lshlrev_b32 v112, 16, v48
    v_and_b32 v113, 0xffff0000, v48
    v_lshlrev_b32 v114, 16, v49
    v_and_b32 v115, 0xffff0000, v49
    v_lshlrev_b32 v116, 16, v50
    v_and_b32 v117, 0xffff0000, v50
    v_lshlrev_b32 v118, 16, v51
    v_and_b32 v119, 0xffff0000, v51
    v_lshlrev_b32 v120, 16, v52
    v_and_b32 v121, 0xffff0000, v52
    v_lshlrev_b32 v122, 16, v53
    v_and_b32 v123, 0xffff0000, v53
    v_lshlrev_b32 v124, 16, v54
    v_and_b32 v125, 0xffff0000, v54
    v_lshlrev_b32 v126, 16, v55
    v_and_b32 v127, 0xffff0000, v55
    v_lshlrev_b32 v128, 16, v56
    v_and_b32 v129, 0xffff0000, v56
    v_lshlrev_b32 v130, 16, v57
    v_and_b32 v131, 0xffff0000, v57
    v_lshlrev_b32 v132, 16, v58
    v_and_b32 v133, 0xffff0000, v58
    v_lshlrev_b32 v134, 16, v59
    v_and_b32 v135, 0xffff0000, v59
    s_mov_b32 m0, s31
    s_cmp_eq_u32 s3, 2
    s_cselect_b32 s26, 0, s26
    buffer_load_dwordx4 v212, s[24:27], s67 offen offset:0 sc1 lds
    buffer_load_dwordx4 v213, s[24:27], s67 offen offset:1024 sc1 lds
    buffer_load_dwordx4 v214, s[24:27], s67 offen offset:2048 sc1 lds
    buffer_load_dwordx4 v215, s[24:27], s67 offen offset:3072 sc1 lds
    s_add_u32 m0, m0, 4096
    s_add_u32 s67, s67, 294912
    buffer_load_dwordx4 v212, s[24:27], s67 offen offset:0 sc1 lds
    buffer_load_dwordx4 v213, s[24:27], s67 offen offset:1024 sc1 lds
    buffer_load_dwordx4 v214, s[24:27], s67 offen offset:2048 sc1 lds
    buffer_load_dwordx4 v215, s[24:27], s67 offen offset:3072 sc1 lds
    s_add_u32 s67, s67, 294912
    s_add_u32 m0, s31, 32768
    s_nop 0
    buffer_load_dwordx4 v212, s[24:27], s67 offen offset:0 sc1 lds
    buffer_load_dwordx4 v213, s[24:27], s67 offen offset:1024 sc1 lds
    buffer_load_dwordx4 v214, s[24:27], s67 offen offset:2048 sc1 lds
    buffer_load_dwordx4 v215, s[24:27], s67 offen offset:3072 sc1 lds
    s_add_u32 m0, m0, 4096
    s_add_u32 s67, s67, 294912
    buffer_load_dwordx4 v212, s[24:27], s67 offen offset:0 sc1 lds
    buffer_load_dwordx4 v213, s[24:27], s67 offen offset:1024 sc1 lds
    buffer_load_dwordx4 v214, s[24:27], s67 offen offset:2048 sc1 lds
    buffer_load_dwordx4 v215, s[24:27], s67 offen offset:3072 sc1 lds
    s_add_u32 s67, s67, 294912
    s_add_u32 m0, s31, 65536
    s_nop 0
    buffer_load_dwordx4 v212, s[24:27], s67 offen offset:0 sc1 lds
    buffer_load_dwordx4 v213, s[24:27], s67 offen offset:1024 sc1 lds
    buffer_load_dwordx4 v214, s[24:27], s67 offen offset:2048 sc1 lds
    buffer_load_dwordx4 v215, s[24:27], s67 offen offset:3072 sc1 lds
    s_add_u32 m0, m0, 4096
    s_add_u32 s67, s67, 294912
    buffer_load_dwordx4 v212, s[24:27], s67 offen offset:0 sc1 lds
    buffer_load_dwordx4 v213, s[24:27], s67 offen offset:1024 sc1 lds
    buffer_load_dwordx4 v214, s[24:27], s67 offen offset:2048 sc1 lds
    buffer_load_dwordx4 v215, s[24:27], s67 offen offset:3072 sc1 lds
    s_add_u32 s67, s67, 294912
    s_branch KP_wload
KP_ln2:

    s_cmp_lg_u32 s6, 0
    s_cbranch_scc1 KP_b_x
    s_mov_b32 s61, 1048576
    s_branch KP_b_f
KP_b:
    s_sleep 2
KP_b_f:
    buffer_load_dword v20, v149, s[20:23], 0 offen sc1
    buffer_load_dword v21, v150, s[20:23], 0 offen sc1
    buffer_load_dword v22, v151, s[20:23], 0 offen sc1
    s_sub_u32 s61, s61, 1
    s_cbranch_scc1 KP_b_x
    s_waitcnt vmcnt(0)
    v_and_b32 v20, v20, v21
    v_and_b32 v20, v20, v22
    v_cmp_ne_u32 vcc, 1, v20
    s_cbranch_vccnz KP_b
KP_b_x:
    s_barrier
    s_mov_b32 s61, 65536
    s_branch KP_y_f
KP_y:
    s_sleep 1
KP_y_f:
    s_mov_b32 s7, s80
    buffer_load_dwordx2 v[24:25], v138, s[20:23], s7 offen sc1
    s_add_u32 s7, s7, 66048
    buffer_load_dwordx2 v[26:27], v138, s[20:23], s7 offen sc1
    s_add_u32 s7, s7, 66048
    buffer_load_dwordx2 v[28:29], v138, s[20:23], s7 offen sc1
    s_add_u32 s7, s7, 66048
    buffer_load_dwordx2 v[30:31], v138, s[20:23], s7 offen sc1
    s_add_u32 s7, s7, 66048
    buffer_load_dwordx2 v[32:33], v138, s[20:23], s7 offen sc1
    s_add_u32 s7, s7, 66048
    buffer_load_dwordx2 v[34:35], v138, s[20:23], s7 offen sc1
    s_add_u32 s7, s7, 66048
    buffer_load_dwordx2 v[36:37], v138, s[20:23], s7 offen sc1
    s_add_u32 s7, s7, 66048
    buffer_load_dwordx2 v[38:39], v138, s[20:23], s7 offen sc1
    s_add_u32 s7, s7, 66048
    buffer_load_dwordx2 v[40:41], v138, s[20:23], s7 offen sc1
    s_add_u32 s7, s7, 66048
    buffer_load_dwordx2 v[42:43], v138, s[20:23], s7 offen sc1
    s_add_u32 s7, s7, 66048
    s_cmp_lg_u32 s78, 0
    s_cbranch_scc1 KP_s1
    buffer_load_dwordx2 v[44:45], v138, s[20:23], s7 offen sc1
    s_add_u32 s7, s7, 66048
    buffer_load_dwordx2 v[46:47], v138, s[20:23], s7 offen sc1
    s_add_u32 s7, s7, 66048
    buffer_load_dwordx2 v[48:49], v138, s[20:23], s7 offen sc1
    s_add_u32 s7, s7, 66048
    buffer_load_dwordx2 v[50:51], v138, s[20:23], s7 offen sc1
    s_add_u32 s7, s7, 66048
    buffer_load_dwordx2 v[52:53], v138, s[20:23], s7 offen sc1
    s_add_u32 s7, s7, 66048
    buffer_load_dwordx2 v[54:55], v138, s[20:23], s7 offen sc1
    s_add_u32 s7, s7, 66048
    buffer_load_dwordx2 v[56:57], v138, s[20:23], s7 offen sc1
    s_add_u32 s7, s7, 66048
    buffer_load_dwordx2 v[58:59], v138, s[20:23], s7 offen sc1
KP_s1:
    s_sub_u32 s61, s61, 1
    s_cbranch_scc1 KP_y_x
    s_waitcnt vmcnt(0)
    v_max3_u32 v20, v24, v25, v26
    v_max3_u32 v20, v20, v27, v28
    v_max3_u32 v20, v20, v29, v30
    v_max3_u32 v20, v20, v31, v32
    v_max3_u32 v20, v20, v33, v34
    v_max3_u32 v20, v20, v35, v36
    v_max3_u32 v20, v20, v37, v38
    v_max3_u32 v20, v20, v39, v40
    v_max3_u32 v20, v20, v41, v42
    v_max_u32 v20, v20, v43
    s_cmp_lg_u32 s78, 0
    s_cbranch_scc1 KP_s2
    v_max3_u32 v20, v20, v44, v45
    v_max3_u32 v20, v20, v46, v47
    v_max3_u32 v20, v20, v48, v49
    v_max3_u32 v20, v20, v50, v51
    v_max3_u32 v20, v20, v52, v53
    v_max3_u32 v20, v20, v54, v55
    v_max3_u32 v20, v20, v56, v57
    v_max3_u32 v20, v20, v58, v59
KP_s2:
    v_cmp_eq_u32 vcc, -1, v20
    s_cbranch_vccnz KP_y
KP_y_x:
    s_waitcnt vmcnt(0)
    s_cmp_eq_u32 s3, 3
    s_cbranch_scc1 KP_y2
    buffer_load_dword v18, v16, s[20:23], 0 offen sc1
KP_y2:
    s_movk_i32 s7, 0x3f80
    s_mov_b32 s30, 1.0
    v_dot2_f32_bf16 v64, v24, s7, v64
    v_dot2_f32_bf16 v65, v24, s30, v65
    v_dot2_f32_bf16 v66, v25, s7, v66
    v_dot2_f32_bf16 v67, v25, s30, v67
    v_dot2_f32_bf16 v68, v26, s7, v68
    v_dot2_f32_bf16 v69, v26, s30, v69
    v_dot2_f32_bf16 v70, v27, s7, v70
    v_dot2_f32_bf16 v71, v27, s30, v71
    v_dot2_f32_bf16 v72, v28, s7, v72
    v_dot2_f32_bf16 v73, v28, s30, v73
    v_dot2_f32_bf16 v74, v29, s7, v74
    v_dot2_f32_bf16 v75, v29, s30, v75
    v_dot2_f32_bf16 v76, v30, s7, v76
    v_dot2_f32_bf16 v77, v30, s30, v77
    v_pk_mul_f32 v[22:23], v[72:73], v[72:73]
    v_dot2_f32_bf16 v78, v31, s7, v78
    v_dot2_f32_bf16 v79, v31, s30, v79
    v_pk_add_f32 v[20:21], v[72:73], v[74:75]
    v_pk_fma_f32 v[22:23], v[74:75], v[74:75], v[22:23]
    v_dot2_f32_bf16 v80, v32, s7, v80
    v_dot2_f32_bf16 v81, v32, s30, v81
    v_pk_add_f32 v[20:21], v[20:21], v[76:77]
    v_pk_fma_f32 v[22:23], v[76:77], v[76:77], v[22:23]
    v_dot2_f32_bf16 v82, v33, s7, v82
    v_dot2_f32_bf16 v83, v33, s30, v83
    v_pk_add_f32 v[20:21], v[20:21], v[78:79]
    v_pk_fma_f32 v[22:23], v[78:79], v[78:79], v[22:23]
    v_dot2_f32_bf16 v84, v34, s7, v84
    v_dot2_f32_bf16 v85, v34, s30, v85
    v_pk_add_f32 v[20:21], v[20:21], v[80:81]
    v_pk_fma_f32 v[22:23], v[80:81], v[80:81], v[22:23]
    v_dot2_f32_bf16 v86, v35, s7, v86
    v_dot2_f32_bf16 v87, v35, s30, v87
    v_pk_add_f32 v[20:21], v[20:21], v[82:83]
    v_pk_fma_f32 v[22:23], v[82:83], v[82:83], v[22:23]
    v_dot2_f32_bf16 v88, v36, s7, v88
    v_dot2_f32_bf16 v89, v36, s30, v89
    v_pk_add_f32 v[20:21], v[20:21], v[84:85]
    v_pk_fma_f32 v[22:23], v[84:85], v[84:85], v[22:23]
    v_dot2_f32_bf16 v90, v37, s7, v90
    v_dot2_f32_bf16 v91, v37, s30, v91
    v_pk_add_f32 v[20:21], v[20:21], v[86:87]
    v_pk_fma_f32 v[22:23], v[86:87], v[86:87], v[22:23]
    v_dot2_f32_bf16 v92, v38, s7, v92
    v_dot2_f32_bf16 v93, v38, s30, v93
    v_pk_add_f32 v[20:21], v[20:21], v[88:89]
    v_pk_fma_f32 v[22:23], v[88:89], v[88:89], v[22:23]
    v_dot2_f32_bf16 v94, v39, s7, v94
    v_dot2_f32_bf16 v95, v39, s30, v95
    v_pk_add_f32 v[20:21], v[20:21], v[90:91]
    v_pk_fma_f32 v[22:23], v[90:91], v[90:91], v[22:23]
    v_dot2_f32_bf16 v96, v40, s7, v96
    v_dot2_f32_bf16 v97, v40, s30, v97
    v_pk_add_f32 v[20:21], v[20:21], v[92:93]
    v_pk_fma_f32 v[22:23], v[92:93], v[92:93], v[22:23]
    v_dot2_f32_bf16 v98, v41, s7, v98
    v_dot2_f32_bf16 v99, v41, s30, v99
    v_pk_add_f32 v[20:21], v[20:21], v[94:95]
    v_pk_fma_f32 v[22:23], v[94:95], v[94:95], v[22:23]
    v_dot2_f32_bf16 v100, v42, s7, v100
    v_dot2_f32_bf16 v101, v42, s30, v101
    v_pk_add_f32 v[20:21], v[20:21], v[96:97]
    v_pk_fma_f32 v[22:23], v[96:97], v[96:97], v[22:23]
    v_dot2_f32_bf16 v102, v43, s7, v102
    v_dot2_f32_bf16 v103, v43, s30, v103
    v_pk_add_f32 v[20:21], v[20:21], v[98:99]
    v_pk_fma_f32 v[22:23], v[98:99], v[98:99], v[22:23]
    v_pk_add_f32 v[20:21], v[20:21], v[100:101]
    v_pk_fma_f32 v[22:23], v[100:101], v[100:101], v[22:23]
    v_pk_add_f32 v[20:21], v[20:21], v[102:103]
    v_pk_fma_f32 v[22:23], v[102:103], v[102:103], v[22:23]
    s_cmp_eq_u32 s78, 3
    s_cbranch_scc1 KP_s3
    v_pk_add_f32 v[20:21], v[20:21], v[64:65]
    v_pk_fma_f32 v[22:23], v[64:65], v[64:65], v[22:23]
    v_pk_add_f32 v[20:21], v[20:21], v[66:67]
    v_pk_fma_f32 v[22:23], v[66:67], v[66:67], v[22:23]
    v_pk_add_f32 v[20:21], v[20:21], v[68:69]
    v_pk_fma_f32 v[22:23], v[68:69], v[68:69], v[22:23]
    v_pk_add_f32 v[20:21], v[20:21], v[70:71]
    v_pk_fma_f32 v[22:23], v[70:71], v[70:71], v[22:23]
    s_cmp_lg_u32 s78, 0
    s_cbranch_scc1 KP_s3
    v_dot2_f32_bf16 v104, v44, s7, v104
    v_dot2_f32_bf16 v105, v44, s30, v105
    v_dot2_f32_bf16 v106, v45, s7, v106
    v_dot2_f32_bf16 v107, v45, s30, v107
    v_dot2_f32_bf16 v108, v46, s7, v108
    v_dot2_f32_bf16 v109, v46, s30, v109
    v_pk_add_f32 v[20:21], v[20:21], v[104:105]
    v_pk_fma_f32 v[22:23], v[104:105], v[104:105], v[22:23]
    v_dot2_f32_bf16 v110, v47, s7, v110
    v_dot2_f32_bf16 v111, v47, s30, v111
    v_pk_add_f32 v[20:21], v[20:21], v[106:107]
    v_pk_fma_f32 v[22:23], v[106:107], v[106:107], v[22:23]
    v_dot2_f32_bf16 v112, v48, s7, v112
    v_dot2_f32_bf16 v113, v48, s30, v113
    v_pk_add_f32 v[20:21], v[20:21], v[108:109]
    v_pk_fma_f32 v[22:23], v[108:109], v[108:109], v[22:23]
    v_dot2_f32_bf16 v114, v49, s7, v114
    v_dot2_f32_bf16 v115, v49, s30, v115
    v_pk_add_f32 v[20:21], v[20:21], v[110:111]
    v_pk_fma_f32 v[22:23], v[110:111], v[110:111], v[22:23]
    v_dot2_f32_bf16 v116, v50, s7, v116
    v_dot2_f32_bf16 v117, v50, s30, v117
    v_pk_add_f32 v[20:21], v[20:21], v[112:113]
    v_pk_fma_f32 v[22:23], v[112:113], v[112:113], v[22:23]
    v_dot2_f32_bf16 v118, v51, s7, v118
    v_dot2_f32_bf16 v119, v51, s30, v119
    v_pk_add_f32 v[20:21], v[20:21], v[114:115]
    v_pk_fma_f32 v[22:23], v[114:115], v[114:115], v[22:23]
    v_dot2_f32_bf16 v120, v52, s7, v120
    v_dot2_f32_bf16 v121, v52, s30, v121
    v_pk_add_f32 v[20:21], v[20:21], v[116:117]
    v_pk_fma_f32 v[22:23], v[116:117], v[116:117], v[22:23]
    v_dot2_f32_bf16 v122, v53, s7, v122
    v_dot2_f32_bf16 v123, v53, s30, v123
    v_pk_add_f32 v[20:21], v[20:21], v[118:119]
    v_pk_fma_f32 v[22:23], v[118:119], v[118:119], v[22:23]
    v_dot2_f32_bf16 v124, v54, s7, v124
    v_dot2_f32_bf16 v125, v54, s30, v125
    v_pk_add_f32 v[20:21], v[20:21], v[120:121]
    v_pk_fma_f32 v[22:23], v[120:121], v[120:121], v[22:23]
    v_dot2_f32_bf16 v126, v55, s7, v126
    v_dot2_f32_bf16 v127, v55, s30, v127
    v_pk_add_f32 v[20:21], v[20:21], v[122:123]
    v_pk_fma_f32 v[22:23], v[122:123], v[122:123], v[22:23]
    v_dot2_f32_bf16 v128, v56, s7, v128
    v_dot2_f32_bf16 v129, v56, s30, v129
    v_pk_add_f32 v[20:21], v[20:21], v[124:125]
    v_pk_fma_f32 v[22:23], v[124:125], v[124:125], v[22:23]
    v_dot2_f32_bf16 v130, v57, s7, v130
    v_dot2_f32_bf16 v131, v57, s30, v131
    v_pk_add_f32 v[20:21], v[20:21], v[126:127]
    v_pk_fma_f32 v[22:23], v[126:127], v[126:127], v[22:23]
    v_dot2_f32_bf16 v132, v58, s7, v132
    v_dot2_f32_bf16 v133, v58, s30, v133
    v_pk_add_f32 v[20:21], v[20:21], v[128:129]
    v_pk_fma_f32 v[22:23], v[128:129], v[128:129], v[22:23]
    v_dot2_f32_bf16 v134, v59, s7, v134
    v_dot2_f32_bf16 v135, v59, s30, v135
    v_pk_add_f32 v[20:21], v[20:21], v[130:131]
    v_pk_fma_f32 v[22:23], v[130:131], v[130:131], v[22:23]
    v_pk_add_f32 v[20:21], v[20:21], v[132:133]
    v_pk_fma_f32 v[22:23], v[132:133], v[132:133], v[22:23]
    v_pk_add_f32 v[20:21], v[20:21], v[134:135]
    v_pk_fma_f32 v[22:23], v[134:135], v[134:135], v[22:23]
KP_s3:
    v_add_f32 v20, v20, v21
    v_add_f32 v22, v22, v23
    v_mov_b32 v21, v20
    v_mov_b32 v23, v22
    s_nop 0
    v_permlane16_swap_b32 v20, v21
    v_permlane16_swap_b32 v22, v23
    v_add_f32 v20, v20, v21
    v_add_f32 v22, v22, v23
    v_mov_b32 v21, v20
    v_mov_b32 v23, v22
    s_nop 0
    v_permlane32_swap_b32 v20, v21
    v_permlane32_swap_b32 v22, v23
    v_add_f32 v20, v20, v21
    v_add_f32 v22, v22, v23
    v_mov_b32 v21, v22
    ds_write_b64 v136, v[20:21]
    s_cmp_lg_u32 s78, 0
    s_cselect_b64 vcc, -1, 0
    s_waitcnt lgkmcnt(0)
    s_barrier
    ds_read_b64 v[24:25], v137
    ds_read_b64 v[26:27], v146
    ds_read_b64 v[28:29], v147
    s_waitcnt lgkmcnt(0)
    v_pk_add_f32 v[20:21], v[20:21], v[24:25]
    v_pk_add_f32 v[26:27], v[26:27], v[28:29]
    v_cndmask_b32 v26, 0, v26, vcc
    v_cndmask_b32 v27, 0, v27, vcc
    v_add_f32 v20, v20, v26
    v_add_f32 v22, v21, v27
    v_mul_f32 v20, 0x3ae38e39, v20
    v_mul_f32 v21, v20, v20
    v_mul_f32 v22, 0x3ae38e39, v22
    v_sub_f32 v22, v22, v21
    v_max_f32 v22, 0, v22
    v_cvt_pk_bf16_f32 v22, v22, v22
    v_and_b32 v22, 0xffff0000, v22
    v_add_f32 v22, 0x3727c5ac, v22
    v_cvt_pk_bf16_f32 v22, v22, v22
    v_and_b32 v22, 0xffff0000, v22
    v_sqrt_f32 v22, v22
    v_cvt_pk_bf16_f32 v20, v20, v20
    v_and_b32 v20, 0xffff0000, v20
    v_cvt_pk_bf16_f32 v22, v22, v22
    v_and_b32 v22, 0xffff0000, v22
    v_rcp_f32 v22, v22
    s_nop 0
    v_mul_f32 v20, v20, v22
    v_pk_fma_f32 v[64:65], v[64:65], v[22:23], v[20:21] op_sel_hi:[1,0,0] neg_lo:[0,0,1] neg_hi:[0,0,1]
    v_pk_fma_f32 v[66:67], v[66:67], v[22:23], v[20:21] op_sel_hi:[1,0,0] neg_lo:[0,0,1] neg_hi:[0,0,1]
    v_pk_fma_f32 v[68:69], v[68:69], v[22:23], v[20:21] op_sel_hi:[1,0,0] neg_lo:[0,0,1] neg_hi:[0,0,1]
    v_pk_fma_f32 v[70:71], v[70:71], v[22:23], v[20:21] op_sel_hi:[1,0,0] neg_lo:[0,0,1] neg_hi:[0,0,1]
    v_cvt_pk_bf16_f32 v24, v64, v65
    v_cvt_pk_bf16_f32 v25, v66, v67
    v_cvt_pk_bf16_f32 v26, v68, v69
    v_cvt_pk_bf16_f32 v27, v70, v71
    buffer_store_dwordx4 v[24:27], v139, s[20:23], s81 offen offset:0 sc1
    v_pk_fma_f32 v[72:73], v[72:73], v[22:23], v[20:21] op_sel_hi:[1,0,0] neg_lo:[0,0,1] neg_hi:[0,0,1]
    v_pk_fma_f32 v[74:75], v[74:75], v[22:23], v[20:21] op_sel_hi:[1,0,0] neg_lo:[0,0,1] neg_hi:[0,0,1]
    v_pk_fma_f32 v[76:77], v[76:77], v[22:23], v[20:21] op_sel_hi:[1,0,0] neg_lo:[0,0,1] neg_hi:[0,0,1]
    v_pk_fma_f32 v[78:79], v[78:79], v[22:23], v[20:21] op_sel_hi:[1,0,0] neg_lo:[0,0,1] neg_hi:[0,0,1]
    v_cvt_pk_bf16_f32 v28, v72, v73
    v_cvt_pk_bf16_f32 v29, v74, v75
    v_cvt_pk_bf16_f32 v30, v76, v77
    v_cvt_pk_bf16_f32 v31, v78, v79
    buffer_store_dwordx4 v[28:31], v139, s[20:23], s81 offen offset:1024 sc1
    v_pk_fma_f32 v[80:81], v[80:81], v[22:23], v[20:21] op_sel_hi:[1,0,0] neg_lo:[0,0,1] neg_hi:[0,0,1]
    v_pk_fma_f32 v[82:83], v[82:83], v[22:23], v[20:21] op_sel_hi:[1,0,0] neg_lo:[0,0,1] neg_hi:[0,0,1]
    v_pk_fma_f32 v[84:85], v[84:85], v[22:23], v[20:21] op_sel_hi:[1,0,0] neg_lo:[0,0,1] neg_hi:[0,0,1]
    v_pk_fma_f32 v[86:87], v[86:87], v[22:23], v[20:21] op_sel_hi:[1,0,0] neg_lo:[0,0,1] neg_hi:[0,0,1]
    v_cvt_pk_bf16_f32 v32, v80, v81
    v_cvt_pk_bf16_f32 v33, v82, v83
    v_cvt_pk_bf16_f32 v34, v84, v85
    v_cvt_pk_bf16_f32 v35, v86, v87
    buffer_store_dwordx4 v[32:35], v139, s[20:23], s81 offen offset:2048 sc1
    v_pk_fma_f32 v[88:89], v[88:89], v[22:23], v[20:21] op_sel_hi:[1,0,0] neg_lo:[0,0,1] neg_hi:[0,0,1]
    v_pk_fma_f32 v[90:91], v[90:91], v[22:23], v[20:21] op_sel_hi:[1,0,0] neg_lo:[0,0,1] neg_hi:[0,0,1]
    v_pk_fma_f32 v[92:93], v[92:93], v[22:23], v[20:21] op_sel_hi:[1,0,0] neg_lo:[0,0,1] neg_hi:[0,0,1]
    v_pk_fma_f32 v[94:95], v[94:95], v[22:23], v[20:21] op_sel_hi:[1,0,0] neg_lo:[0,0,1] neg_hi:[0,0,1]
    v_cvt_pk_bf16_f32 v36, v88, v89
    v_cvt_pk_bf16_f32 v37, v90, v91
    v_cvt_pk_bf16_f32 v38, v92, v93
    v_cvt_pk_bf16_f32 v39, v94, v95
    buffer_store_dwordx4 v[36:39], v139, s[20:23], s81 offen offset:3072 sc1
    s_add_u32 s81, s81, 4096
    v_pk_fma_f32 v[96:97], v[96:97], v[22:23], v[20:21] op_sel_hi:[1,0,0] neg_lo:[0,0,1] neg_hi:[0,0,1]
    v_pk_fma_f32 v[98:99], v[98:99], v[22:23], v[20:21] op_sel_hi:[1,0,0] neg_lo:[0,0,1] neg_hi:[0,0,1]
    v_pk_fma_f32 v[100:101], v[100:101], v[22:23], v[20:21] op_sel_hi:[1,0,0] neg_lo:[0,0,1] neg_hi:[0,0,1]
    v_pk_fma_f32 v[102:103], v[102:103], v[22:23], v[20:21] op_sel_hi:[1,0,0] neg_lo:[0,0,1] neg_hi:[0,0,1]
    v_cvt_pk_bf16_f32 v40, v96, v97
    v_cvt_pk_bf16_f32 v41, v98, v99
    v_cvt_pk_bf16_f32 v42, v100, v101
    v_cvt_pk_bf16_f32 v43, v102, v103
    buffer_store_dwordx4 v[40:43], v139, s[20:23], s81 offen offset:0 sc1
    s_cmp_lg_u32 s78, 0
    s_cbranch_scc1 KP_s4
    v_pk_fma_f32 v[104:105], v[104:105], v[22:23], v[20:21] op_sel_hi:[1,0,0] neg_lo:[0,0,1] neg_hi:[0,0,1]
    v_pk_fma_f32 v[106:107], v[106:107], v[22:23], v[20:21] op_sel_hi:[1,0,0] neg_lo:[0,0,1] neg_hi:[0,0,1]
    v_pk_fma_f32 v[108:109], v[108:109], v[22:23], v[20:21] op_sel_hi:[1,0,0] neg_lo:[0,0,1] neg_hi:[0,0,1]
    v_pk_fma_f32 v[110:111], v[110:111], v[22:23], v[20:21] op_sel_hi:[1,0,0] neg_lo:[0,0,1] neg_hi:[0,0,1]
    v_cvt_pk_bf16_f32 v44, v104, v105
    v_cvt_pk_bf16_f32 v45, v106, v107
    v_cvt_pk_bf16_f32 v46, v108, v109
    v_cvt_pk_bf16_f32 v47, v110, v111
    buffer_store_dwordx4 v[44:47], v139, s[20:23], s81 offen offset:1024 sc1
    v_pk_fma_f32 v[112:113], v[112:113], v[22:23], v[20:21] op_sel_hi:[1,0,0] neg_lo:[0,0,1] neg_hi:[0,0,1]
    v_pk_fma_f32 v[114:115], v[114:115], v[22:23], v[20:21] op_sel_hi:[1,0,0] neg_lo:[0,0,1] neg_hi:[0,0,1]
    v_pk_fma_f32 v[116:117], v[116:117], v[22:23], v[20:21] op_sel_hi:[1,0,0] neg_lo:[0,0,1] neg_hi:[0,0,1]
    v_pk_fma_f32 v[118:119], v[118:119], v[22:23], v[20:21] op_sel_hi:[1,0,0] neg_lo:[0,0,1] neg_hi:[0,0,1]
    v_cvt_pk_bf16_f32 v48, v112, v113
    v_cvt_pk_bf16_f32 v49, v114, v115
    v_cvt_pk_bf16_f32 v50, v116, v117
    v_cvt_pk_bf16_f32 v51, v118, v119
    buffer_store_dwordx4 v[48:51], v139, s[20:23], s81 offen offset:2048 sc1
    v_pk_fma_f32 v[120:121], v[120:121], v[22:23], v[20:21] op_sel_hi:[1,0,0] neg_lo:[0,0,1] neg_hi:[0,0,1]
    v_pk_fma_f32 v[122:123], v[122:123], v[22:23], v[20:21] op_sel_hi:[1,0,0] neg_lo:[0,0,1] neg_hi:[0,0,1]
    v_pk_fma_f32 v[124:125], v[124:125], v[22:23], v[20:21] op_sel_hi:[1,0,0] neg_lo:[0,0,1] neg_hi:[0,0,1]
    v_pk_fma_f32 v[126:127], v[126:127], v[22:23], v[20:21] op_sel_hi:[1,0,0] neg_lo:[0,0,1] neg_hi:[0,0,1]
    v_cvt_pk_bf16_f32 v52, v120, v121
    v_cvt_pk_bf16_f32 v53, v122, v123
    v_cvt_pk_bf16_f32 v54, v124, v125
    v_cvt_pk_bf16_f32 v55, v126, v127
    buffer_store_dwordx4 v[52:55], v139, s[20:23], s81 offen offset:3072 sc1
    s_add_u32 s81, s81, 4096
    v_pk_fma_f32 v[128:129], v[128:129], v[22:23], v[20:21] op_sel_hi:[1,0,0] neg_lo:[0,0,1] neg_hi:[0,0,1]
    v_pk_fma_f32 v[130:131], v[130:131], v[22:23], v[20:21] op_sel_hi:[1,0,0] neg_lo:[0,0,1] neg_hi:[0,0,1]
    v_pk_fma_f32 v[132:133], v[132:133], v[22:23], v[20:21] op_sel_hi:[1,0,0] neg_lo:[0,0,1] neg_hi:[0,0,1]
    v_pk_fma_f32 v[134:135], v[134:135], v[22:23], v[20:21] op_sel_hi:[1,0,0] neg_lo:[0,0,1] neg_hi:[0,0,1]
    v_cvt_pk_bf16_f32 v56, v128, v129
    v_cvt_pk_bf16_f32 v57, v130, v131
    v_cvt_pk_bf16_f32 v58, v132, v133
    v_cvt_pk_bf16_f32 v59, v134, v135
    buffer_store_dwordx4 v[56:59], v139, s[20:23], s81 offen offset:0 sc1
KP_s4:
    v_mov_b32 v60, 1
    s_cmp_eq_u32 s3, 3
    s_cbranch_scc1 KP_wret
    s_cmp_eq_u32 s3, 3
    s_cbranch_scc1 KP_y3
    s_waitcnt vmcnt(5)
    v_cmp_ne_u32 vcc, 1, v18
    s_cbranch_vccnz KP_y3
    s_call_b64 s[82:83], KP_xi
    s_waitcnt vmcnt(10)
    s_branch KP_y4
KP_y3:
    s_waitcnt vmcnt(0)
KP_y4:
    s_barrier
    buffer_store_dword v60, v148, s[20:23], 0 offen sc1
    s_cmp_eq_u32 s3, 3
    s_cbranch_scc1 KP_wret
    s_branch KP_xs
PG_2_prev_end:
    .p2align 12
PG_2:
    s_setpc_b64 s[82:83]
PG_2_go:

    s_cmp_lt_u32 s6, 2
    s_cselect_b32 s24, s12, s14
    s_cselect_b32 s25, s13, s15
    s_mov_b32 s26, 5308416
    s_mov_b32 s27, 0x00020000
    s_mov_b64 s[4:5], s[10:11]
    s_mov_b64 s[20:21], s[10:11]
    s_mov_b32 s22, 0x10000000
    s_mov_b32 s23, 0x00020000
    s_mov_b64 s[68:69], s[8:9]
    s_movk_i32 s70, 256
    s_mov_b32 s71, 0x00020000
    s_mul_i32 s33, s6, 29040
    v_lshl_add_u32 v3, v1, 3, s33
    v_bfe_u32 v10, v1, 3, 2
    v_mov_b32 v11, 0x76543210
    v_mov_b32 v12, 0x44322210
    v_cmp_eq_u32 vcc, 1, v10
    v_mov_b32 v13, 0x54214310
    v_and_b32 v14, 7, v1
    v_cndmask_b32 v11, v11, v12, vcc
    v_cmp_eq_u32 vcc, 2, v10
    v_mov_b32 v12, 0x32103210
    v_lshlrev_b32 v15, 2, v14
    v_cndmask_b32 v11, v11, v13, vcc
    v_cmp_eq_u32 vcc, 3, v10
    v_lshlrev_b32 v16, 3, v10
    s_mov_b32 s7, 0x130d0800
    v_cndmask_b32 v11, v11, v12, vcc
    v_bfe_u32 v11, v11, v15, 4
    v_bfe_u32 v16, s7, v16, 8
    v_add_u32 v11, v16, v11
    v_lshrrev_b32 v12, 5, v1
    v_lshl_add_u32 v13, v12, 4, s33
    s_movk_i32 s7, 528
    v_mad_u32_u24 v66, v11, s7, v13
    v_and_b32 v10, 31, v1
    v_mad_u32_u24 v68, v10, s7, v13
    v_add_u32 v68, 12144, v68
    s_mul_i32 s13, s6, 9248
    s_add_u32 s13, s13, 126848
    s_add_u32 s7, s13, 568
    v_lshlrev_b32 v10, 4, v10
    v_lshl_add_u32 v10, v12, 3, v10
    v_sub_u32 v69, s7, v10
    v_lshl_add_u32 v67, v1, 1, s13
    v_cmp_lt_u32 vcc, 31, v1
    v_mov_b32 v63, s13
    v_lshrrev_b32 v10, 4, v1
    v_cndmask_b32 v67, 2.0, v67, vcc
    v_cmp_eq_u32 vcc, 63, v1
    v_lshl_add_u32 v62, v1, 4, s13
    s_nop 0
    v_cndmask_b32 v63, 2.0, v63, vcc
    v_cmp_gt_u32 vcc, 4, v1
    s_nop 1
    v_cndmask_b32 v62, 2.0, v62, vcc
    v_mul_u32_u24 v10, 2240, v10
    v_and_b32 v11, 15, v1
    v_lshl_add_u32 v10, v11, 2, v10
    v_add_u32 v65, s13, v10
    v_mov_b32 v12, 0x3f80
    v_mov_b32 v13, 0x3f80
    ds_write_b64 v3, v[12:13] offset:12144
    v_and_b32 v56, 15, v1
    v_lshrrev_b32 v54, 4, v1
    v_lshrrev_b32 v55, 2, v56
    v_lshlrev_b32 v53, 1, v54
    v_sub_u32 v53, v53, v55
    v_lshlrev_b32 v53, 3, v53
    v_and_b32 v199, 3, v56
    v_mul_u32_u24 v199, 2240, v199
    v_sub_u32 v53, v53, v199
    s_add_u32 s16, s13, 6744
    v_add_u32 v199, s16, v53
    v_lshlrev_b32 v53, 2, v54
    v_sub_u32 v53, v56, v53
    s_add_u32 s16, s13, 8884
    v_lshl_add_u32 v2, v53, 2, s16
    v_lshl_add_u32 v57, v56, 1, v54
    v_add_u32 v57, 1550, v57
    v_lshrrev_b32 v58, 2, v57
    v_xor_b32 v58, s6, v58
    v_and_b32 v58, 3, v58
    v_lshlrev_b32 v58, 4, v58
    v_lshl_add_u32 v192, v57, 6, v58
    v_add_u32 v57, -4, v57
    v_lshrrev_b32 v58, 2, v57
    v_xor_b32 v58, s6, v58
    v_and_b32 v58, 3, v58
    v_lshlrev_b32 v58, 4, v58
    v_lshl_add_u32 v193, v57, 6, v58
    v_add_u32 v57, -4, v57
    v_lshrrev_b32 v58, 2, v57
    v_xor_b32 v58, s6, v58
    v_and_b32 v58, 3, v58
    v_lshlrev_b32 v58, 4, v58
    v_lshl_add_u32 v194, v57, 6, v58
    v_add_u32 v57, -4, v57
    v_lshrrev_b32 v58, 2, v57
    v_xor_b32 v58, s6, v58
    v_and_b32 v58, 3, v58
    v_lshlrev_b32 v58, 4, v58
    v_lshl_add_u32 v195, v57, 6, v58
    v_lshlrev_b32 v53, 3, v54
    v_sub_u32 v53, v53, v56
    s_mov_b32 s16, 0x10001
    s_mov_b32 s17, 0x7f0000
    v_add_u32 v52, 11, v53
    v_med3_i32 v52, v52, 0, 31
    v_lshrrev_b32 v52, v52, s17
    v_and_b32 v52, 255, v52
    v_lshl_or_b32 v52, v52, 15, v52
    v_and_b32 v51, s16, v52
    v_mul_u32_u24 v224, 0x3f80, v51
    v_lshrrev_b32 v51, 2, v52
    v_and_b32 v51, s16, v51
    v_mul_u32_u24 v225, 0x3f80, v51
    v_lshrrev_b32 v51, 4, v52
    v_and_b32 v51, s16, v51
    v_mul_u32_u24 v226, 0x3f80, v51
    v_lshrrev_b32 v51, 6, v52
    v_and_b32 v51, s16, v51
    v_mul_u32_u24 v227, 0x3f80, v51
    s_mov_b32 s17, 0x1ff0000
    v_add_u32 v52, 20, v53
    v_med3_i32 v52, v52, 0, 31
    v_lshrrev_b32 v52, v52, s17
    v_and_b32 v52, 255, v52
    v_lshl_or_b32 v52, v52, 15, v52
    v_and_b32 v51, s16, v52
    v_mul_u32_u24 v228, 0x3f80, v51
    v_lshrrev_b32 v51, 2, v52
    v_and_b32 v51, s16, v51
    v_mul_u32_u24 v229, 0x3f80, v51
    v_lshrrev_b32 v51, 4, v52
    v_and_b32 v51, s16, v51
    v_mul_u32_u24 v230, 0x3f80, v51
    v_lshrrev_b32 v51, 6, v52
    v_and_b32 v51, s16, v51
    v_mul_u32_u24 v231, 0x3f80, v51
    s_mov_b32 s17, 0x1ff0000
    v_add_u32 v52, -12, v53
    v_med3_i32 v52, v52, 0, 31
    v_lshrrev_b32 v52, v52, s17
    v_and_b32 v52, 255, v52
    v_lshl_or_b32 v52, v52, 15, v52
    v_and_b32 v51, s16, v52
    v_mul_u32_u24 v232, 0x3f80, v51
    v_lshrrev_b32 v51, 2, v52
    v_and_b32 v51, s16, v51
    v_mul_u32_u24 v233, 0x3f80, v51
    v_lshrrev_b32 v51, 4, v52
    v_and_b32 v51, s16, v51
    v_mul_u32_u24 v234, 0x3f80, v51
    v_lshrrev_b32 v51, 6, v52
    v_and_b32 v51, s16, v51
    v_mul_u32_u24 v235, 0x3f80, v51
    s_lshl_b32 s7, s29, 1
    s_and_b32 s8, s6, 1
    s_add_u32 s7, s7, s8
    s_add_u32 s7, s7, 0
    s_lshl_b32 s7, s7, 6
    v_add_u32 v216, s7, v1
    v_mul_u32_u24 v217, 52429, v216
    v_lshrrev_b32 v217, 19, v217
    v_mul_u32_u24 v217, 7936, v217
    v_lshl_add_u32 v217, v216, 7, v217
    buffer_load_dword v218, v217, s[24:27], s28 offen
    v_lshlrev_b32 v198, 3, v0
    v_add_u32 v198, 98304, v198
    v_lshrrev_b32 v58, 1, v54
    v_lshl_add_u32 v58, v58, 1, v1
    v_lshl_add_u32 v205, v58, 3, s13
    s_mul_i32 s17, s6, 2336
    s_add_u32 s17, s17, 116736
    v_lshl_add_u32 v204, v58, 3, s17
    v_and_b32 v58, 3, v1
    v_lshrrev_b32 v59, 1, v58
    v_lshlrev_b32 v58, 4, v58
    v_lshl_add_u32 v58, v59, 1, v58
    v_add_u32 v58, v58, v54
    s_mul_i32 s17, s6, 576
    v_lshl_add_u32 v58, v58, 3, s17
    v_bfe_u32 v59, v1, 2, 2
    v_mul_u32_u24 v207, 9248, v59
    v_mul_u32_u24 v206, 2336, v59
    v_add_u32 v207, 126848, v207
    v_add_u32 v206, 116736, v206
    v_add_u32 v207, v207, v58
    v_add_u32 v206, v206, v58
    v_mov_b32 v197, 1
    v_lshrrev_b32 v58, 3, v1
    v_mul_u32_u24 v212, 9216, v58
    v_lshrrev_b32 v58, 4, v1
    v_lshrrev_b32 v59, 1, v1
    v_xor_b32 v58, v58, v59
    v_and_b32 v58, 3, v58
    v_lshl_add_u32 v212, v58, 5, v212
    v_and_b32 v58, 1, v1
    v_lshl_add_u32 v212, v58, 4, v212
    v_add_u32 v213, 72704, v212
    v_add_u32 v214, 145408, v212
    v_add_u32 v215, 218112, v212
    v_lshrrev_b32 v58, 2, v1
    v_lshlrev_b32 v208, 7, v58
    v_and_b32 v59, 3, v1
    v_lshl_add_u32 v208, v59, 3, v208
    s_lshr_b32 s30, s6, 1
    s_lshl_b32 s30, s30, 13
    v_add_u32 v208, s30, v208
    v_bfe_u32 v58, v1, 3, 2
    s_and_b32 s30, s6, 1
    s_lshl_b32 s30, s30, 1
    v_xor_b32 v58, s30, v58
    v_lshl_add_u32 v208, v58, 5, v208
    v_xor_b32 v209, 32, v208
    v_add_u32 v210, 65536, v208
    v_add_u32 v211, 65536, v209
    s_mov_b32 s66, 0
    s_lshl_b32 s7, s65, 7
    s_add_u32 s7, s7, 47808512
    v_mov_b32 v196, s7
    v_cmp_eq_u32 vcc, 0, v0
    v_mov_b32 v58, -1
    s_nop 0
    v_cndmask_b32 v196, 2.0, v196, vcc
    s_mov_b32 s16, 18432
    v_and_b32 v201, 15, v1
    v_lshlrev_b32 v201, 7, v201
    s_min_u32 s7, s6, 2
    s_lshl_b32 s7, s7, 11
    s_add_u32 s7, s7, 47886336
    v_add_u32 v202, s7, v201
    s_lshl_b32 s7, s6, 11
    s_add_u32 s7, s7, 47878144
    v_add_u32 v201, s7, v201
    v_lshlrev_b32 v203, 4, v1
    s_waitcnt lgkmcnt(0)
    s_lshl_b32 s8, s6, 4
    s_lshr_b64 s[76:77], s[76:77], s8
    s_lshl_b32 s76, s76, 16
    s_lshr_b64 s[78:79], s[78:79], s8
    s_lshl_b32 s78, s78, 16
    v_mov_b32 v10, 0x3fb8aa3b
    v_mul_f32 v11, s76, v10
    v_exp_f32 v11, v11
    s_nop 0
    v_cvt_pk_bf16_f32 v11, v11, v11
    v_and_b32 v11, 0xffff0000, v11
    s_waitcnt vmcnt(1)
    s_mul_i32 s8, s65, 16512
    s_lshl_b32 s9, s6, 11
    s_add_u32 s8, s8, s9
    s_add_u32 s18, s8, 4718592
    v_lshlrev_b32 v64, 4, v1
    v_mov_b64 v[220:221], -1
    v_mov_b64 v[222:223], -1
    v_lshlrev_b32 v84, 16, v70
    v_and_b32 v148, 0xffff0000, v70
    v_lshlrev_b32 v85, 16, v71
    v_and_b32 v149, 0xffff0000, v71
    v_lshlrev_b32 v86, 16, v72
    v_and_b32 v150, 0xffff0000, v72
    v_lshlrev_b32 v87, 16, v73
    v_and_b32 v151, 0xffff0000, v73
    v_lshlrev_b32 v88, 16, v74
    v_and_b32 v152, 0xffff0000, v74
    v_lshlrev_b32 v89, 16, v75
    v_and_b32 v153, 0xffff0000, v75
    v_mul_f32 v84, v11, v84
    v_mul_f32 v85, v11, v85
    v_mul_f32 v86, v11, v86
    v_mul_f32 v87, v11, v87
    v_mul_f32 v84, v10, v84
    v_mul_f32 v85, 0.15915494, v85
    v_mul_f32 v148, v11, v148
    v_mul_f32 v149, v11, v149
    v_mul_f32 v150, v11, v150
    v_mul_f32 v151, v11, v151
    v_mul_f32 v148, v10, v148
    v_mul_f32 v149, 0.15915494, v149
    v_ldexp_f32 v96, v85, 0
    v_ldexp_f32 v97, v84, 0
    v_fract_f32 v96, v96
    v_exp_f32 v97, v97
    v_ldexp_f32 v160, v149, 0
    v_ldexp_f32 v161, v148, 0
    v_fract_f32 v160, v160
    v_exp_f32 v161, v161
    v_cos_f32 v90, v96
    v_sin_f32 v91, v96
    v_cos_f32 v154, v160
    v_sin_f32 v155, v160
    v_pk_mul_f32 v[90:91], v[90:91], v[96:97] op_sel:[0,1] op_sel_hi:[1,1]
    v_pk_mul_f32 v[154:155], v[154:155], v[160:161] op_sel:[0,1] op_sel_hi:[1,1]
    v_ldexp_f32 v96, v85, 3
    v_ldexp_f32 v97, v84, 3
    v_fract_f32 v96, v96
    v_exp_f32 v97, v97
    v_ldexp_f32 v160, v149, 3
    v_ldexp_f32 v161, v148, 3
    v_fract_f32 v160, v160
    v_exp_f32 v161, v161
    v_cos_f32 v92, v96
    v_sin_f32 v93, v96
    v_cos_f32 v156, v160
    v_sin_f32 v157, v160
    v_pk_mul_f32 v[92:93], v[92:93], v[96:97] op_sel:[0,1] op_sel_hi:[1,1]
    v_pk_mul_f32 v[156:157], v[156:157], v[160:161] op_sel:[0,1] op_sel_hi:[1,1]
    v_ldexp_f32 v96, v85, 8
    v_ldexp_f32 v97, v84, 8
    v_fract_f32 v96, v96
    v_exp_f32 v97, v97
    v_ldexp_f32 v160, v149, 8
    v_ldexp_f32 v161, v148, 8
    v_fract_f32 v160, v160
    v_exp_f32 v161, v161
    v_cos_f32 v94, v96
    v_sin_f32 v95, v96
    v_cos_f32 v158, v160
    v_sin_f32 v159, v160
    v_pk_mul_f32 v[94:95], v[94:95], v[96:97] op_sel:[0,1] op_sel_hi:[1,1]
    v_pk_mul_f32 v[158:159], v[158:159], v[160:161] op_sel:[0,1] op_sel_hi:[1,1]
    v_cvt_pk_bf16_f32 v50, v92, v93
    v_cvt_pk_bf16_f32 v51, v156, v157
    ds_write_b64 v3, v[50:51] offset:12672
    v_pk_mul_f32 v[98:99], v[88:89], v[86:87] op_sel_hi:[0,1]
    v_pk_mul_f32 v[162:163], v[152:153], v[150:151] op_sel_hi:[0,1]
    v_pk_fma_f32 v[100:101], v[88:89], v[86:87], v[98:99] op_sel:[1,1,0] op_sel_hi:[1,0,1] neg_lo:[1,0,0]
    v_pk_fma_f32 v[164:165], v[152:153], v[150:151], v[162:163] op_sel:[1,1,0] op_sel_hi:[1,0,1] neg_lo:[1,0,0]
    v_cvt_pk_bf16_f32 v52, v100, -v101
    v_cvt_pk_bf16_f32 v53, v164, -v165
    ds_write_b64 v3, v[52:53] offset:0
    v_pk_mul_f32 v[96:97], v[100:101], v[90:91] op_sel_hi:[0,1]
    v_pk_mul_f32 v[160:161], v[164:165], v[154:155] op_sel_hi:[0,1]
    v_pk_fma_f32 v[102:103], v[100:101], v[90:91], v[96:97] op_sel:[1,1,0] op_sel_hi:[1,0,1] neg_lo:[1,0,0]
    v_pk_fma_f32 v[166:167], v[164:165], v[154:155], v[160:161] op_sel:[1,1,0] op_sel_hi:[1,0,1] neg_lo:[1,0,0]
    v_cvt_pk_bf16_f32 v54, v102, -v103
    v_cvt_pk_bf16_f32 v55, v166, -v167
    ds_write_b64 v3, v[54:55] offset:528
    v_pk_mul_f32 v[98:99], v[102:103], v[90:91] op_sel_hi:[0,1]
    v_pk_mul_f32 v[162:163], v[166:167], v[154:155] op_sel_hi:[0,1]
    v_pk_fma_f32 v[104:105], v[102:103], v[90:91], v[98:99] op_sel:[1,1,0] op_sel_hi:[1,0,1] neg_lo:[1,0,0]
    v_pk_fma_f32 v[168:169], v[166:167], v[154:155], v[162:163] op_sel:[1,1,0] op_sel_hi:[1,0,1] neg_lo:[1,0,0]
    v_cvt_pk_bf16_f32 v56, v104, -v105
    v_cvt_pk_bf16_f32 v57, v168, -v169
    ds_write_b64 v3, v[56:57] offset:1056
    v_pk_mul_f32 v[96:97], v[104:105], v[90:91] op_sel_hi:[0,1]
    v_pk_mul_f32 v[160:161], v[168:169], v[154:155] op_sel_hi:[0,1]
    v_pk_fma_f32 v[106:107], v[104:105], v[90:91], v[96:97] op_sel:[1,1,0] op_sel_hi:[1,0,1] neg_lo:[1,0,0]
    v_pk_fma_f32 v[170:171], v[168:169], v[154:155], v[160:161] op_sel:[1,1,0] op_sel_hi:[1,0,1] neg_lo:[1,0,0]
    v_cvt_pk_bf16_f32 v58, v106, -v107
    v_cvt_pk_bf16_f32 v59, v170, -v171
    ds_write_b64 v3, v[58:59] offset:1584
    v_pk_mul_f32 v[98:99], v[106:107], v[90:91] op_sel_hi:[0,1]
    v_pk_mul_f32 v[162:163], v[170:171], v[154:155] op_sel_hi:[0,1]
    v_pk_fma_f32 v[108:109], v[106:107], v[90:91], v[98:99] op_sel:[1,1,0] op_sel_hi:[1,0,1] neg_lo:[1,0,0]
    v_pk_fma_f32 v[172:173], v[170:171], v[154:155], v[162:163] op_sel:[1,1,0] op_sel_hi:[1,0,1] neg_lo:[1,0,0]
    v_cvt_pk_bf16_f32 v60, v108, -v109
    v_cvt_pk_bf16_f32 v61, v172, -v173
    ds_write_b64 v3, v[60:61] offset:2112
    v_pk_mul_f32 v[96:97], v[108:109], v[90:91] op_sel_hi:[0,1]
    v_pk_mul_f32 v[160:161], v[172:173], v[154:155] op_sel_hi:[0,1]
    v_pk_fma_f32 v[110:111], v[108:109], v[90:91], v[96:97] op_sel:[1,1,0] op_sel_hi:[1,0,1] neg_lo:[1,0,0]
    v_pk_fma_f32 v[174:175], v[172:173], v[154:155], v[160:161] op_sel:[1,1,0] op_sel_hi:[1,0,1] neg_lo:[1,0,0]
    v_cvt_pk_bf16_f32 v50, v110, -v111
    v_cvt_pk_bf16_f32 v51, v174, -v175
    ds_write_b64 v3, v[50:51] offset:2640
    v_pk_mul_f32 v[98:99], v[110:111], v[90:91] op_sel_hi:[0,1]
    v_pk_mul_f32 v[162:163], v[174:175], v[154:155] op_sel_hi:[0,1]
    v_pk_fma_f32 v[112:113], v[110:111], v[90:91], v[98:99] op_sel:[1,1,0] op_sel_hi:[1,0,1] neg_lo:[1,0,0]
    v_pk_fma_f32 v[176:177], v[174:175], v[154:155], v[162:163] op_sel:[1,1,0] op_sel_hi:[1,0,1] neg_lo:[1,0,0]
    v_cvt_pk_bf16_f32 v52, v112, -v113
    v_cvt_pk_bf16_f32 v53, v176, -v177
    ds_write_b64 v3, v[52:53] offset:3168
    v_pk_mul_f32 v[96:97], v[112:113], v[90:91] op_sel_hi:[0,1]
    v_pk_mul_f32 v[160:161], v[176:177], v[154:155] op_sel_hi:[0,1]
    v_pk_fma_f32 v[114:115], v[112:113], v[90:91], v[96:97] op_sel:[1,1,0] op_sel_hi:[1,0,1] neg_lo:[1,0,0]
    v_pk_fma_f32 v[178:179], v[176:177], v[154:155], v[160:161] op_sel:[1,1,0] op_sel_hi:[1,0,1] neg_lo:[1,0,0]
    v_cvt_pk_bf16_f32 v54, v114, -v115
    v_cvt_pk_bf16_f32 v55, v178, -v179
    ds_write_b64 v3, v[54:55] offset:3696
    v_pk_mul_f32 v[98:99], v[114:115], v[90:91] op_sel_hi:[0,1]
    v_pk_mul_f32 v[162:163], v[178:179], v[154:155] op_sel_hi:[0,1]
    v_pk_fma_f32 v[116:117], v[114:115], v[90:91], v[98:99] op_sel:[1,1,0] op_sel_hi:[1,0,1] neg_lo:[1,0,0]
    v_pk_fma_f32 v[180:181], v[178:179], v[154:155], v[162:163] op_sel:[1,1,0] op_sel_hi:[1,0,1] neg_lo:[1,0,0]
    v_pk_mul_f32 v[96:97], v[100:101], v[94:95] op_sel_hi:[0,1]
    v_pk_mul_f32 v[160:161], v[164:165], v[158:159] op_sel_hi:[0,1]
    v_pk_fma_f32 v[100:101], v[100:101], v[94:95], v[96:97] op_sel:[1,1,0] op_sel_hi:[1,0,1] neg_lo:[1,0,0]
    v_pk_fma_f32 v[164:165], v[164:165], v[158:159], v[160:161] op_sel:[1,1,0] op_sel_hi:[1,0,1] neg_lo:[1,0,0]
    v_cvt_pk_bf16_f32 v58, v100, -v101
    v_cvt_pk_bf16_f32 v59, v164, -v165
    ds_write_b64 v3, v[58:59] offset:4224
    v_pk_mul_f32 v[98:99], v[104:105], v[94:95] op_sel_hi:[0,1]
    v_pk_mul_f32 v[162:163], v[168:169], v[158:159] op_sel_hi:[0,1]
    v_pk_fma_f32 v[104:105], v[104:105], v[94:95], v[98:99] op_sel:[1,1,0] op_sel_hi:[1,0,1] neg_lo:[1,0,0]
    v_pk_fma_f32 v[168:169], v[168:169], v[158:159], v[162:163] op_sel:[1,1,0] op_sel_hi:[1,0,1] neg_lo:[1,0,0]
    v_cvt_pk_bf16_f32 v60, v104, -v105
    v_cvt_pk_bf16_f32 v61, v168, -v169
    ds_write_b64 v3, v[60:61] offset:4752
    v_pk_mul_f32 v[96:97], v[108:109], v[94:95] op_sel_hi:[0,1]
    v_pk_mul_f32 v[160:161], v[172:173], v[158:159] op_sel_hi:[0,1]
    v_pk_fma_f32 v[108:109], v[108:109], v[94:95], v[96:97] op_sel:[1,1,0] op_sel_hi:[1,0,1] neg_lo:[1,0,0]
    v_pk_fma_f32 v[172:173], v[172:173], v[158:159], v[160:161] op_sel:[1,1,0] op_sel_hi:[1,0,1] neg_lo:[1,0,0]
    v_cvt_pk_bf16_f32 v50, v108, -v109
    v_cvt_pk_bf16_f32 v51, v172, -v173
    ds_write_b64 v3, v[50:51] offset:5280
    v_pk_mul_f32 v[98:99], v[112:113], v[94:95] op_sel_hi:[0,1]
    v_pk_mul_f32 v[162:163], v[176:177], v[158:159] op_sel_hi:[0,1]
    v_pk_fma_f32 v[112:113], v[112:113], v[94:95], v[98:99] op_sel:[1,1,0] op_sel_hi:[1,0,1] neg_lo:[1,0,0]
    v_pk_fma_f32 v[176:177], v[176:177], v[158:159], v[162:163] op_sel:[1,1,0] op_sel_hi:[1,0,1] neg_lo:[1,0,0]
    v_cvt_pk_bf16_f32 v52, v112, -v113
    v_cvt_pk_bf16_f32 v53, v176, -v177
    ds_write_b64 v3, v[52:53] offset:5808
    v_pk_mul_f32 v[96:97], v[116:117], v[94:95] op_sel_hi:[0,1]
    v_pk_mul_f32 v[160:161], v[180:181], v[158:159] op_sel_hi:[0,1]
    v_pk_fma_f32 v[116:117], v[116:117], v[94:95], v[96:97] op_sel:[1,1,0] op_sel_hi:[1,0,1] neg_lo:[1,0,0]
    v_pk_fma_f32 v[180:181], v[180:181], v[158:159], v[160:161] op_sel:[1,1,0] op_sel_hi:[1,0,1] neg_lo:[1,0,0]
    v_cvt_pk_bf16_f32 v54, v116, -v117
    v_cvt_pk_bf16_f32 v55, v180, -v181
    ds_write_b64 v3, v[54:55] offset:6336
    v_pk_mul_f32 v[98:99], v[100:101], v[94:95] op_sel_hi:[0,1]
    v_pk_mul_f32 v[162:163], v[164:165], v[158:159] op_sel_hi:[0,1]
    v_pk_fma_f32 v[100:101], v[100:101], v[94:95], v[98:99] op_sel:[1,1,0] op_sel_hi:[1,0,1] neg_lo:[1,0,0]
    v_pk_fma_f32 v[164:165], v[164:165], v[158:159], v[162:163] op_sel:[1,1,0] op_sel_hi:[1,0,1] neg_lo:[1,0,0]
    v_cvt_pk_bf16_f32 v56, v100, -v101
    v_cvt_pk_bf16_f32 v57, v164, -v165
    ds_write_b64 v3, v[56:57] offset:6864
    v_pk_mul_f32 v[96:97], v[108:109], v[94:95] op_sel_hi:[0,1]
    v_pk_mul_f32 v[160:161], v[172:173], v[158:159] op_sel_hi:[0,1]
    v_pk_fma_f32 v[108:109], v[108:109], v[94:95], v[96:97] op_sel:[1,1,0] op_sel_hi:[1,0,1] neg_lo:[1,0,0]
    v_pk_fma_f32 v[172:173], v[172:173], v[158:159], v[160:161] op_sel:[1,1,0] op_sel_hi:[1,0,1] neg_lo:[1,0,0]
    v_cvt_pk_bf16_f32 v58, v108, -v109
    v_cvt_pk_bf16_f32 v59, v172, -v173
    ds_write_b64 v3, v[58:59] offset:7392
    v_pk_mul_f32 v[98:99], v[116:117], v[94:95] op_sel_hi:[0,1]
    v_pk_mul_f32 v[162:163], v[180:181], v[158:159] op_sel_hi:[0,1]
    v_pk_fma_f32 v[116:117], v[116:117], v[94:95], v[98:99] op_sel:[1,1,0] op_sel_hi:[1,0,1] neg_lo:[1,0,0]
    v_pk_fma_f32 v[180:181], v[180:181], v[158:159], v[162:163] op_sel:[1,1,0] op_sel_hi:[1,0,1] neg_lo:[1,0,0]
    v_cvt_pk_bf16_f32 v60, v116, -v117
    v_cvt_pk_bf16_f32 v61, v180, -v181
    ds_write_b64 v3, v[60:61] offset:7920
    v_pk_mul_f32 v[96:97], v[100:101], v[94:95] op_sel_hi:[0,1]
    v_pk_mul_f32 v[160:161], v[164:165], v[158:159] op_sel_hi:[0,1]
    v_pk_fma_f32 v[100:101], v[100:101], v[94:95], v[96:97] op_sel:[1,1,0] op_sel_hi:[1,0,1] neg_lo:[1,0,0]
    v_pk_fma_f32 v[164:165], v[164:165], v[158:159], v[160:161] op_sel:[1,1,0] op_sel_hi:[1,0,1] neg_lo:[1,0,0]
    v_cvt_pk_bf16_f32 v50, v100, -v101
    v_cvt_pk_bf16_f32 v51, v164, -v165
    ds_write_b64 v3, v[50:51] offset:8448
    v_pk_mul_f32 v[98:99], v[108:109], v[94:95] op_sel_hi:[0,1]
    v_pk_mul_f32 v[162:163], v[172:173], v[158:159] op_sel_hi:[0,1]
    v_pk_fma_f32 v[108:109], v[108:109], v[94:95], v[98:99] op_sel:[1,1,0] op_sel_hi:[1,0,1] neg_lo:[1,0,0]
    v_pk_fma_f32 v[172:173], v[172:173], v[158:159], v[162:163] op_sel:[1,1,0] op_sel_hi:[1,0,1] neg_lo:[1,0,0]
    v_cvt_pk_bf16_f32 v52, v108, -v109
    v_cvt_pk_bf16_f32 v53, v172, -v173
    ds_write_b64 v3, v[52:53] offset:8976
    v_pk_mul_f32 v[96:97], v[116:117], v[94:95] op_sel_hi:[0,1]
    v_pk_mul_f32 v[160:161], v[180:181], v[158:159] op_sel_hi:[0,1]
    v_pk_fma_f32 v[116:117], v[116:117], v[94:95], v[96:97] op_sel:[1,1,0] op_sel_hi:[1,0,1] neg_lo:[1,0,0]
    v_pk_fma_f32 v[180:181], v[180:181], v[158:159], v[160:161] op_sel:[1,1,0] op_sel_hi:[1,0,1] neg_lo:[1,0,0]
    v_cvt_pk_bf16_f32 v54, v116, -v117
    v_cvt_pk_bf16_f32 v55, v180, -v181
    ds_write_b64 v3, v[54:55] offset:9504
    v_pk_mul_f32 v[98:99], v[116:117], v[94:95] op_sel_hi:[0,1]
    v_pk_mul_f32 v[162:163], v[180:181], v[158:159] op_sel_hi:[0,1]
    v_pk_fma_f32 v[116:117], v[116:117], v[94:95], v[98:99] op_sel:[1,1,0] op_sel_hi:[1,0,1] neg_lo:[1,0,0]
    v_pk_fma_f32 v[180:181], v[180:181], v[158:159], v[162:163] op_sel:[1,1,0] op_sel_hi:[1,0,1] neg_lo:[1,0,0]
    v_cvt_pk_bf16_f32 v56, v116, -v117
    v_cvt_pk_bf16_f32 v57, v180, -v181
    ds_write_b64 v3, v[56:57] offset:10032
    v_pk_mul_f32 v[96:97], v[116:117], v[94:95] op_sel_hi:[0,1]
    v_pk_mul_f32 v[160:161], v[180:181], v[158:159] op_sel_hi:[0,1]
    v_pk_fma_f32 v[116:117], v[116:117], v[94:95], v[96:97] op_sel:[1,1,0] op_sel_hi:[1,0,1] neg_lo:[1,0,0]
    v_pk_fma_f32 v[180:181], v[180:181], v[158:159], v[160:161] op_sel:[1,1,0] op_sel_hi:[1,0,1] neg_lo:[1,0,0]
    v_cvt_pk_bf16_f32 v58, v116, -v117
    v_cvt_pk_bf16_f32 v59, v180, -v181
    ds_write_b64 v3, v[58:59] offset:10560
    v_pk_mul_f32 v[98:99], v[116:117], v[94:95] op_sel_hi:[0,1]
    v_pk_mul_f32 v[162:163], v[180:181], v[158:159] op_sel_hi:[0,1]
    v_pk_fma_f32 v[116:117], v[116:117], v[94:95], v[98:99] op_sel:[1,1,0] op_sel_hi:[1,0,1] neg_lo:[1,0,0]
    v_pk_fma_f32 v[180:181], v[180:181], v[158:159], v[162:163] op_sel:[1,1,0] op_sel_hi:[1,0,1] neg_lo:[1,0,0]
    v_cvt_pk_bf16_f32 v60, v116, -v117
    v_cvt_pk_bf16_f32 v61, v180, -v181
    ds_write_b64 v3, v[60:61] offset:11088
    v_pk_mul_f32 v[96:97], v[116:117], v[94:95] op_sel_hi:[0,1]
    v_pk_mul_f32 v[160:161], v[180:181], v[158:159] op_sel_hi:[0,1]
    v_pk_fma_f32 v[116:117], v[116:117], v[94:95], v[96:97] op_sel:[1,1,0] op_sel_hi:[1,0,1] neg_lo:[1,0,0]
    v_pk_fma_f32 v[180:181], v[180:181], v[158:159], v[160:161] op_sel:[1,1,0] op_sel_hi:[1,0,1] neg_lo:[1,0,0]
    v_cvt_pk_bf16_f32 v50, v116, -v117
    v_cvt_pk_bf16_f32 v51, v180, -v181
    ds_write_b64 v3, v[50:51] offset:11616
    v_pk_mul_f32 v[98:99], v[92:93], v[92:93] op_sel_hi:[0,1]
    v_pk_mul_f32 v[162:163], v[156:157], v[156:157] op_sel_hi:[0,1]
    v_pk_fma_f32 v[118:119], v[92:93], v[92:93], v[98:99] op_sel:[1,1,0] op_sel_hi:[1,0,1] neg_lo:[1,0,0]
    v_pk_fma_f32 v[182:183], v[156:157], v[156:157], v[162:163] op_sel:[1,1,0] op_sel_hi:[1,0,1] neg_lo:[1,0,0]
    v_cvt_pk_bf16_f32 v52, v118, v119
    v_cvt_pk_bf16_f32 v53, v182, v183
    ds_write_b64 v3, v[52:53] offset:13200
    v_pk_mul_f32 v[96:97], v[92:93], v[118:119] op_sel_hi:[0,1]
    v_pk_mul_f32 v[160:161], v[156:157], v[182:183] op_sel_hi:[0,1]
    v_pk_fma_f32 v[120:121], v[92:93], v[118:119], v[96:97] op_sel:[1,1,0] op_sel_hi:[1,0,1] neg_lo:[1,0,0]
    v_pk_fma_f32 v[184:185], v[156:157], v[182:183], v[160:161] op_sel:[1,1,0] op_sel_hi:[1,0,1] neg_lo:[1,0,0]
    v_cvt_pk_bf16_f32 v54, v120, v121
    v_cvt_pk_bf16_f32 v55, v184, v185
    ds_write_b64 v3, v[54:55] offset:13728
    v_pk_mul_f32 v[98:99], v[118:119], v[118:119] op_sel_hi:[0,1]
    v_pk_mul_f32 v[162:163], v[182:183], v[182:183] op_sel_hi:[0,1]
    v_pk_fma_f32 v[122:123], v[118:119], v[118:119], v[98:99] op_sel:[1,1,0] op_sel_hi:[1,0,1] neg_lo:[1,0,0]
    v_pk_fma_f32 v[186:187], v[182:183], v[182:183], v[162:163] op_sel:[1,1,0] op_sel_hi:[1,0,1] neg_lo:[1,0,0]
    v_cvt_pk_bf16_f32 v56, v122, v123
    v_cvt_pk_bf16_f32 v57, v186, v187
    ds_write_b64 v3, v[56:57] offset:14256
    v_pk_mul_f32 v[96:97], v[120:121], v[118:119] op_sel_hi:[0,1]
    v_pk_mul_f32 v[160:161], v[184:185], v[182:183] op_sel_hi:[0,1]
    v_pk_fma_f32 v[120:121], v[120:121], v[118:119], v[96:97] op_sel:[1,1,0] op_sel_hi:[1,0,1] neg_lo:[1,0,0]
    v_pk_fma_f32 v[184:185], v[184:185], v[182:183], v[160:161] op_sel:[1,1,0] op_sel_hi:[1,0,1] neg_lo:[1,0,0]
    v_cvt_pk_bf16_f32 v58, v120, v121
    v_cvt_pk_bf16_f32 v59, v184, v185
    ds_write_b64 v3, v[58:59] offset:14784
    v_pk_mul_f32 v[98:99], v[122:123], v[118:119] op_sel_hi:[0,1]
    v_pk_mul_f32 v[162:163], v[186:187], v[182:183] op_sel_hi:[0,1]
    v_pk_fma_f32 v[122:123], v[122:123], v[118:119], v[98:99] op_sel:[1,1,0] op_sel_hi:[1,0,1] neg_lo:[1,0,0]
    v_pk_fma_f32 v[186:187], v[186:187], v[182:183], v[162:163] op_sel:[1,1,0] op_sel_hi:[1,0,1] neg_lo:[1,0,0]
    v_cvt_pk_bf16_f32 v60, v122, v123
    v_cvt_pk_bf16_f32 v61, v186, v187
    ds_write_b64 v3, v[60:61] offset:15312
    v_pk_mul_f32 v[96:97], v[120:121], v[118:119] op_sel_hi:[0,1]
    v_pk_mul_f32 v[160:161], v[184:185], v[182:183] op_sel_hi:[0,1]
    v_pk_fma_f32 v[120:121], v[120:121], v[118:119], v[96:97] op_sel:[1,1,0] op_sel_hi:[1,0,1] neg_lo:[1,0,0]
    v_pk_fma_f32 v[184:185], v[184:185], v[182:183], v[160:161] op_sel:[1,1,0] op_sel_hi:[1,0,1] neg_lo:[1,0,0]
    v_cvt_pk_bf16_f32 v50, v120, v121
    v_cvt_pk_bf16_f32 v51, v184, v185
    ds_write_b64 v3, v[50:51] offset:15840
    v_pk_mul_f32 v[98:99], v[122:123], v[118:119] op_sel_hi:[0,1]
    v_pk_mul_f32 v[162:163], v[186:187], v[182:183] op_sel_hi:[0,1]
    v_pk_fma_f32 v[122:123], v[122:123], v[118:119], v[98:99] op_sel:[1,1,0] op_sel_hi:[1,0,1] neg_lo:[1,0,0]
    v_pk_fma_f32 v[186:187], v[186:187], v[182:183], v[162:163] op_sel:[1,1,0] op_sel_hi:[1,0,1] neg_lo:[1,0,0]
    v_cvt_pk_bf16_f32 v52, v122, v123
    v_cvt_pk_bf16_f32 v53, v186, v187
    ds_write_b64 v3, v[52:53] offset:16368
    v_pk_mul_f32 v[96:97], v[120:121], v[118:119] op_sel_hi:[0,1]
    v_pk_mul_f32 v[160:161], v[184:185], v[182:183] op_sel_hi:[0,1]
    v_pk_fma_f32 v[120:121], v[120:121], v[118:119], v[96:97] op_sel:[1,1,0] op_sel_hi:[1,0,1] neg_lo:[1,0,0]
    v_pk_fma_f32 v[184:185], v[184:185], v[182:183], v[160:161] op_sel:[1,1,0] op_sel_hi:[1,0,1] neg_lo:[1,0,0]
    v_cvt_pk_bf16_f32 v54, v120, v121
    v_cvt_pk_bf16_f32 v55, v184, v185
    ds_write_b64 v3, v[54:55] offset:16896
    v_pk_mul_f32 v[98:99], v[122:123], v[118:119] op_sel_hi:[0,1]
    v_pk_mul_f32 v[162:163], v[186:187], v[182:183] op_sel_hi:[0,1]
    v_pk_fma_f32 v[122:123], v[122:123], v[118:119], v[98:99] op_sel:[1,1,0] op_sel_hi:[1,0,1] neg_lo:[1,0,0]
    v_pk_fma_f32 v[186:187], v[186:187], v[182:183], v[162:163] op_sel:[1,1,0] op_sel_hi:[1,0,1] neg_lo:[1,0,0]
    v_cvt_pk_bf16_f32 v56, v122, v123
    v_cvt_pk_bf16_f32 v57, v186, v187
    ds_write_b64 v3, v[56:57] offset:17424
    v_pk_mul_f32 v[96:97], v[120:121], v[118:119] op_sel_hi:[0,1]
    v_pk_mul_f32 v[160:161], v[184:185], v[182:183] op_sel_hi:[0,1]
    v_pk_fma_f32 v[120:121], v[120:121], v[118:119], v[96:97] op_sel:[1,1,0] op_sel_hi:[1,0,1] neg_lo:[1,0,0]
    v_pk_fma_f32 v[184:185], v[184:185], v[182:183], v[160:161] op_sel:[1,1,0] op_sel_hi:[1,0,1] neg_lo:[1,0,0]
    v_cvt_pk_bf16_f32 v58, v120, v121
    v_cvt_pk_bf16_f32 v59, v184, v185
    ds_write_b64 v3, v[58:59] offset:17952
    v_pk_mul_f32 v[98:99], v[122:123], v[118:119] op_sel_hi:[0,1]
    v_pk_mul_f32 v[162:163], v[186:187], v[182:183] op_sel_hi:[0,1]
    v_pk_fma_f32 v[122:123], v[122:123], v[118:119], v[98:99] op_sel:[1,1,0] op_sel_hi:[1,0,1] neg_lo:[1,0,0]
    v_pk_fma_f32 v[186:187], v[186:187], v[182:183], v[162:163] op_sel:[1,1,0] op_sel_hi:[1,0,1] neg_lo:[1,0,0]
    v_cvt_pk_bf16_f32 v60, v122, v123
    v_cvt_pk_bf16_f32 v61, v186, v187
    ds_write_b64 v3, v[60:61] offset:18480
    v_pk_mul_f32 v[96:97], v[120:121], v[118:119] op_sel_hi:[0,1]
    v_pk_mul_f32 v[160:161], v[184:185], v[182:183] op_sel_hi:[0,1]
    v_pk_fma_f32 v[120:121], v[120:121], v[118:119], v[96:97] op_sel:[1,1,0] op_sel_hi:[1,0,1] neg_lo:[1,0,0]
    v_pk_fma_f32 v[184:185], v[184:185], v[182:183], v[160:161] op_sel:[1,1,0] op_sel_hi:[1,0,1] neg_lo:[1,0,0]
    v_cvt_pk_bf16_f32 v50, v120, v121
    v_cvt_pk_bf16_f32 v51, v184, v185
    ds_write_b64 v3, v[50:51] offset:19008
    v_pk_mul_f32 v[98:99], v[122:123], v[118:119] op_sel_hi:[0,1]
    v_pk_mul_f32 v[162:163], v[186:187], v[182:183] op_sel_hi:[0,1]
    v_pk_fma_f32 v[122:123], v[122:123], v[118:119], v[98:99] op_sel:[1,1,0] op_sel_hi:[1,0,1] neg_lo:[1,0,0]
    v_pk_fma_f32 v[186:187], v[186:187], v[182:183], v[162:163] op_sel:[1,1,0] op_sel_hi:[1,0,1] neg_lo:[1,0,0]
    v_cvt_pk_bf16_f32 v52, v122, v123
    v_cvt_pk_bf16_f32 v53, v186, v187
    ds_write_b64 v3, v[52:53] offset:19536
    s_branch PG_3_go
PG_3_prev_end:
    .p2align 12
PG_3:
    s_setpc_b64 s[82:83]
PG_3_go:
    v_pk_mul_f32 v[96:97], v[120:121], v[118:119] op_sel_hi:[0,1]
    v_pk_mul_f32 v[160:161], v[184:185], v[182:183] op_sel_hi:[0,1]
    v_pk_fma_f32 v[120:121], v[120:121], v[118:119], v[96:97] op_sel:[1,1,0] op_sel_hi:[1,0,1] neg_lo:[1,0,0]
    v_pk_fma_f32 v[184:185], v[184:185], v[182:183], v[160:161] op_sel:[1,1,0] op_sel_hi:[1,0,1] neg_lo:[1,0,0]
    v_cvt_pk_bf16_f32 v54, v120, v121
    v_cvt_pk_bf16_f32 v55, v184, v185
    ds_write_b64 v3, v[54:55] offset:20064
    v_pk_mul_f32 v[98:99], v[122:123], v[118:119] op_sel_hi:[0,1]
    v_pk_mul_f32 v[162:163], v[186:187], v[182:183] op_sel_hi:[0,1]
    v_pk_fma_f32 v[122:123], v[122:123], v[118:119], v[98:99] op_sel:[1,1,0] op_sel_hi:[1,0,1] neg_lo:[1,0,0]
    v_pk_fma_f32 v[186:187], v[186:187], v[182:183], v[162:163] op_sel:[1,1,0] op_sel_hi:[1,0,1] neg_lo:[1,0,0]
    v_cvt_pk_bf16_f32 v56, v122, v123
    v_cvt_pk_bf16_f32 v57, v186, v187
    ds_write_b64 v3, v[56:57] offset:20592
    v_pk_mul_f32 v[96:97], v[120:121], v[118:119] op_sel_hi:[0,1]
    v_pk_mul_f32 v[160:161], v[184:185], v[182:183] op_sel_hi:[0,1]
    v_pk_fma_f32 v[120:121], v[120:121], v[118:119], v[96:97] op_sel:[1,1,0] op_sel_hi:[1,0,1] neg_lo:[1,0,0]
    v_pk_fma_f32 v[184:185], v[184:185], v[182:183], v[160:161] op_sel:[1,1,0] op_sel_hi:[1,0,1] neg_lo:[1,0,0]
    v_cvt_pk_bf16_f32 v58, v120, v121
    v_cvt_pk_bf16_f32 v59, v184, v185
    ds_write_b64 v3, v[58:59] offset:21120
    v_pk_mul_f32 v[98:99], v[122:123], v[118:119] op_sel_hi:[0,1]
    v_pk_mul_f32 v[162:163], v[186:187], v[182:183] op_sel_hi:[0,1]
    v_pk_fma_f32 v[122:123], v[122:123], v[118:119], v[98:99] op_sel:[1,1,0] op_sel_hi:[1,0,1] neg_lo:[1,0,0]
    v_pk_fma_f32 v[186:187], v[186:187], v[182:183], v[162:163] op_sel:[1,1,0] op_sel_hi:[1,0,1] neg_lo:[1,0,0]
    v_cvt_pk_bf16_f32 v60, v122, v123
    v_cvt_pk_bf16_f32 v61, v186, v187
    ds_write_b64 v3, v[60:61] offset:21648
    v_pk_mul_f32 v[96:97], v[120:121], v[118:119] op_sel_hi:[0,1]
    v_pk_mul_f32 v[160:161], v[184:185], v[182:183] op_sel_hi:[0,1]
    v_pk_fma_f32 v[120:121], v[120:121], v[118:119], v[96:97] op_sel:[1,1,0] op_sel_hi:[1,0,1] neg_lo:[1,0,0]
    v_pk_fma_f32 v[184:185], v[184:185], v[182:183], v[160:161] op_sel:[1,1,0] op_sel_hi:[1,0,1] neg_lo:[1,0,0]
    v_cvt_pk_bf16_f32 v50, v120, v121
    v_cvt_pk_bf16_f32 v51, v184, v185
    ds_write_b64 v3, v[50:51] offset:22176
    v_pk_mul_f32 v[98:99], v[122:123], v[118:119] op_sel_hi:[0,1]
    v_pk_mul_f32 v[162:163], v[186:187], v[182:183] op_sel_hi:[0,1]
    v_pk_fma_f32 v[122:123], v[122:123], v[118:119], v[98:99] op_sel:[1,1,0] op_sel_hi:[1,0,1] neg_lo:[1,0,0]
    v_pk_fma_f32 v[186:187], v[186:187], v[182:183], v[162:163] op_sel:[1,1,0] op_sel_hi:[1,0,1] neg_lo:[1,0,0]
    v_cvt_pk_bf16_f32 v52, v122, v123
    v_cvt_pk_bf16_f32 v53, v186, v187
    ds_write_b64 v3, v[52:53] offset:22704
    v_pk_mul_f32 v[96:97], v[120:121], v[118:119] op_sel_hi:[0,1]
    v_pk_mul_f32 v[160:161], v[184:185], v[182:183] op_sel_hi:[0,1]
    v_pk_fma_f32 v[120:121], v[120:121], v[118:119], v[96:97] op_sel:[1,1,0] op_sel_hi:[1,0,1] neg_lo:[1,0,0]
    v_pk_fma_f32 v[184:185], v[184:185], v[182:183], v[160:161] op_sel:[1,1,0] op_sel_hi:[1,0,1] neg_lo:[1,0,0]
    v_cvt_pk_bf16_f32 v54, v120, v121
    v_cvt_pk_bf16_f32 v55, v184, v185
    ds_write_b64 v3, v[54:55] offset:23232
    v_and_b32 v79, 3, v1
    v_lshlrev_b32 v79, 6, v79
    s_cmp_eq_u32 s6, 0
    s_cselect_b32 s70, 256, 0
    buffer_load_dword v78, v79, s[68:71], 0 offen sc1
    v_pk_mul_f32 v[98:99], v[122:123], v[118:119] op_sel_hi:[0,1]
    v_pk_mul_f32 v[162:163], v[186:187], v[182:183] op_sel_hi:[0,1]
    v_pk_fma_f32 v[122:123], v[122:123], v[118:119], v[98:99] op_sel:[1,1,0] op_sel_hi:[1,0,1] neg_lo:[1,0,0]
    v_pk_fma_f32 v[186:187], v[186:187], v[182:183], v[162:163] op_sel:[1,1,0] op_sel_hi:[1,0,1] neg_lo:[1,0,0]
    v_cvt_pk_bf16_f32 v56, v122, v123
    v_cvt_pk_bf16_f32 v57, v186, v187
    ds_write_b64 v3, v[56:57] offset:23760
    v_pk_mul_f32 v[96:97], v[120:121], v[118:119] op_sel_hi:[0,1]
    v_pk_mul_f32 v[160:161], v[184:185], v[182:183] op_sel_hi:[0,1]
    v_pk_fma_f32 v[120:121], v[120:121], v[118:119], v[96:97] op_sel:[1,1,0] op_sel_hi:[1,0,1] neg_lo:[1,0,0]
    v_pk_fma_f32 v[184:185], v[184:185], v[182:183], v[160:161] op_sel:[1,1,0] op_sel_hi:[1,0,1] neg_lo:[1,0,0]
    v_cvt_pk_bf16_f32 v58, v120, v121
    v_cvt_pk_bf16_f32 v59, v184, v185
    ds_write_b64 v3, v[58:59] offset:24288
    v_pk_mul_f32 v[98:99], v[122:123], v[118:119] op_sel_hi:[0,1]
    v_pk_mul_f32 v[162:163], v[186:187], v[182:183] op_sel_hi:[0,1]
    v_pk_fma_f32 v[122:123], v[122:123], v[118:119], v[98:99] op_sel:[1,1,0] op_sel_hi:[1,0,1] neg_lo:[1,0,0]
    v_pk_fma_f32 v[186:187], v[186:187], v[182:183], v[162:163] op_sel:[1,1,0] op_sel_hi:[1,0,1] neg_lo:[1,0,0]
    v_cvt_pk_bf16_f32 v60, v122, v123
    v_cvt_pk_bf16_f32 v61, v186, v187
    ds_write_b64 v3, v[60:61] offset:24816
    v_pk_mul_f32 v[96:97], v[120:121], v[118:119] op_sel_hi:[0,1]
    v_pk_mul_f32 v[160:161], v[184:185], v[182:183] op_sel_hi:[0,1]
    v_pk_fma_f32 v[120:121], v[120:121], v[118:119], v[96:97] op_sel:[1,1,0] op_sel_hi:[1,0,1] neg_lo:[1,0,0]
    v_pk_fma_f32 v[184:185], v[184:185], v[182:183], v[160:161] op_sel:[1,1,0] op_sel_hi:[1,0,1] neg_lo:[1,0,0]
    v_cvt_pk_bf16_f32 v50, v120, v121
    v_cvt_pk_bf16_f32 v51, v184, v185
    ds_write_b64 v3, v[50:51] offset:25344
    v_pk_mul_f32 v[98:99], v[122:123], v[118:119] op_sel_hi:[0,1]
    v_pk_mul_f32 v[162:163], v[186:187], v[182:183] op_sel_hi:[0,1]
    v_pk_fma_f32 v[122:123], v[122:123], v[118:119], v[98:99] op_sel:[1,1,0] op_sel_hi:[1,0,1] neg_lo:[1,0,0]
    v_pk_fma_f32 v[186:187], v[186:187], v[182:183], v[162:163] op_sel:[1,1,0] op_sel_hi:[1,0,1] neg_lo:[1,0,0]
    v_cvt_pk_bf16_f32 v52, v122, v123
    v_cvt_pk_bf16_f32 v53, v186, v187
    ds_write_b64 v3, v[52:53] offset:25872
    v_pk_mul_f32 v[96:97], v[120:121], v[118:119] op_sel_hi:[0,1]
    v_pk_mul_f32 v[160:161], v[184:185], v[182:183] op_sel_hi:[0,1]
    v_pk_fma_f32 v[120:121], v[120:121], v[118:119], v[96:97] op_sel:[1,1,0] op_sel_hi:[1,0,1] neg_lo:[1,0,0]
    v_pk_fma_f32 v[184:185], v[184:185], v[182:183], v[160:161] op_sel:[1,1,0] op_sel_hi:[1,0,1] neg_lo:[1,0,0]
    v_cvt_pk_bf16_f32 v54, v120, v121
    v_cvt_pk_bf16_f32 v55, v184, v185
    ds_write_b64 v3, v[54:55] offset:26400
    v_pk_mul_f32 v[98:99], v[122:123], v[118:119] op_sel_hi:[0,1]
    v_pk_mul_f32 v[162:163], v[186:187], v[182:183] op_sel_hi:[0,1]
    v_pk_fma_f32 v[122:123], v[122:123], v[118:119], v[98:99] op_sel:[1,1,0] op_sel_hi:[1,0,1] neg_lo:[1,0,0]
    v_pk_fma_f32 v[186:187], v[186:187], v[182:183], v[162:163] op_sel:[1,1,0] op_sel_hi:[1,0,1] neg_lo:[1,0,0]
    v_cvt_pk_bf16_f32 v56, v122, v123
    v_cvt_pk_bf16_f32 v57, v186, v187
    ds_write_b64 v3, v[56:57] offset:26928
    buffer_store_dwordx4 v[220:223], v64, s[20:23], s18 offen offset:0 sc1
    v_pk_mul_f32 v[96:97], v[120:121], v[118:119] op_sel_hi:[0,1]
    v_pk_mul_f32 v[160:161], v[184:185], v[182:183] op_sel_hi:[0,1]
    v_pk_fma_f32 v[120:121], v[120:121], v[118:119], v[96:97] op_sel:[1,1,0] op_sel_hi:[1,0,1] neg_lo:[1,0,0]
    v_pk_fma_f32 v[184:185], v[184:185], v[182:183], v[160:161] op_sel:[1,1,0] op_sel_hi:[1,0,1] neg_lo:[1,0,0]
    v_cvt_pk_bf16_f32 v58, v120, v121
    v_cvt_pk_bf16_f32 v59, v184, v185
    ds_write_b64 v3, v[58:59] offset:27456
    buffer_store_dwordx4 v[220:223], v64, s[20:23], s18 offen offset:1024 sc1
    v_pk_mul_f32 v[98:99], v[122:123], v[118:119] op_sel_hi:[0,1]
    v_pk_mul_f32 v[162:163], v[186:187], v[182:183] op_sel_hi:[0,1]
    v_pk_fma_f32 v[122:123], v[122:123], v[118:119], v[98:99] op_sel:[1,1,0] op_sel_hi:[1,0,1] neg_lo:[1,0,0]
    v_pk_fma_f32 v[186:187], v[186:187], v[182:183], v[162:163] op_sel:[1,1,0] op_sel_hi:[1,0,1] neg_lo:[1,0,0]
    v_cvt_pk_bf16_f32 v60, v122, v123
    v_cvt_pk_bf16_f32 v61, v186, v187
    ds_write_b64 v3, v[60:61] offset:27984
    v_pk_mul_f32 v[96:97], v[120:121], v[118:119] op_sel_hi:[0,1]
    v_pk_mul_f32 v[160:161], v[184:185], v[182:183] op_sel_hi:[0,1]
    v_pk_fma_f32 v[120:121], v[120:121], v[118:119], v[96:97] op_sel:[1,1,0] op_sel_hi:[1,0,1] neg_lo:[1,0,0]
    v_pk_fma_f32 v[184:185], v[184:185], v[182:183], v[160:161] op_sel:[1,1,0] op_sel_hi:[1,0,1] neg_lo:[1,0,0]
    v_cvt_pk_bf16_f32 v50, v120, v121
    v_cvt_pk_bf16_f32 v51, v184, v185
    ds_write_b64 v3, v[50:51] offset:28512
    ds_read_b128 v[84:87], v66 offset:0
    ds_read_b128 v[88:91], v68 offset:0
    ds_read_b128 v[92:95], v66 offset:32
    ds_read_b128 v[96:99], v68 offset:32
    ds_read_b128 v[100:103], v66 offset:64
    ds_read_b128 v[104:107], v68 offset:64
    ds_read_b128 v[108:111], v66 offset:96
    ds_read_b128 v[112:115], v68 offset:96
    s_waitcnt lgkmcnt(6)
    v_mfma_f32_32x32x16_bf16 v[4:19], v[84:87], v[88:91], 0
    ds_read_b128 v[84:87], v66 offset:128
    ds_read_b128 v[88:91], v68 offset:128
    s_waitcnt lgkmcnt(6)
    v_mfma_f32_32x32x16_bf16 v[4:19], v[92:95], v[96:99], v[4:19]
    ds_read_b128 v[92:95], v66 offset:160
    ds_read_b128 v[96:99], v68 offset:160
    s_waitcnt lgkmcnt(6)
    v_mfma_f32_32x32x16_bf16 v[4:19], v[100:103], v[104:107], v[4:19]
    ds_read_b128 v[100:103], v66 offset:192
    ds_read_b128 v[104:107], v68 offset:192
    s_waitcnt lgkmcnt(6)
    v_mfma_f32_32x32x16_bf16 v[4:19], v[108:111], v[112:115], v[4:19]
    ds_read_b128 v[108:111], v66 offset:224
    ds_read_b128 v[112:115], v68 offset:224
    s_waitcnt lgkmcnt(6)
    v_mfma_f32_32x32x16_bf16 v[4:19], v[84:87], v[88:91], v[4:19]
    ds_read_b128 v[84:87], v66 offset:256
    ds_read_b128 v[88:91], v68 offset:256
    s_waitcnt lgkmcnt(6)
    v_mfma_f32_32x32x16_bf16 v[4:19], v[92:95], v[96:99], v[4:19]
    ds_read_b128 v[92:95], v66 offset:288
    ds_read_b128 v[96:99], v68 offset:288
    s_waitcnt lgkmcnt(6)
    v_mfma_f32_32x32x16_bf16 v[4:19], v[100:103], v[104:107], v[4:19]
    ds_read_b128 v[100:103], v66 offset:320
    ds_read_b128 v[104:107], v68 offset:320
    s_waitcnt lgkmcnt(6)
    v_mfma_f32_32x32x16_bf16 v[4:19], v[108:111], v[112:115], v[4:19]
    ds_read_b128 v[108:111], v66 offset:352
    ds_read_b128 v[112:115], v68 offset:352
    s_waitcnt lgkmcnt(6)
    v_mfma_f32_32x32x16_bf16 v[4:19], v[84:87], v[88:91], v[4:19]
    ds_read_b128 v[84:87], v66 offset:384
    ds_read_b128 v[88:91], v68 offset:384
    s_waitcnt lgkmcnt(6)
    v_mfma_f32_32x32x16_bf16 v[4:19], v[92:95], v[96:99], v[4:19]
    ds_read_b128 v[92:95], v66 offset:416
    ds_read_b128 v[96:99], v68 offset:416
    s_waitcnt lgkmcnt(6)
    v_mfma_f32_32x32x16_bf16 v[4:19], v[100:103], v[104:107], v[4:19]
    ds_read_b128 v[100:103], v66 offset:448
    ds_read_b128 v[104:107], v68 offset:448
    s_waitcnt lgkmcnt(6)
    v_mfma_f32_32x32x16_bf16 v[4:19], v[108:111], v[112:115], v[4:19]
    ds_read_b128 v[108:111], v66 offset:480
    ds_read_b128 v[112:115], v68 offset:480
    s_waitcnt lgkmcnt(6)
    v_mfma_f32_32x32x16_bf16 v[4:19], v[84:87], v[88:91], v[4:19]
    s_waitcnt lgkmcnt(4)
    v_mfma_f32_32x32x16_bf16 v[4:19], v[92:95], v[96:99], v[4:19]
    s_waitcnt lgkmcnt(2)
    v_mfma_f32_32x32x16_bf16 v[4:19], v[100:103], v[104:107], v[4:19]
    s_waitcnt lgkmcnt(0)
    v_mfma_f32_32x32x16_bf16 v[4:19], v[108:111], v[112:115], v[4:19]
    s_add_u32 s9, s9, 100352
    s_mov_b32 m0, s9
    s_cmp_lg_u32 s6, 0
    s_cbranch_scc1 KP_r2_x
    s_waitcnt vmcnt(0)
    v_cmp_gt_u32 vcc, 8, v78
    s_cbranch_vccz KP_r2_x
    s_mov_b32 s61, 1048576
KP_r2:
    s_sleep 8
KP_r2_f:
    buffer_load_dword v78, v79, s[68:71], 0 offen sc1
    s_sub_u32 s61, s61, 1
    s_cbranch_scc1 KP_r2_x
    s_waitcnt vmcnt(0)
    v_cmp_gt_u32 vcc, 8, v78
    s_cbranch_vccnz KP_r2
KP_r2_x:
    s_barrier
    buffer_load_dword v200, v201, s[20:23], 0 offen sc1
    s_mov_b64 s[44:45], 1
    s_mov_b32 s46, 0
    s_mov_b32 s47, -1
    v_mov_b32 v36, s78
    v_mov_b64 v[32:33], 0
    v_mov_b64 v[34:35], 0
    v_cndmask_b32 v36, 0, v36, s[44:45]
    ds_write_b32 v65, v32 offset:2112
    ds_write_b128 v62, v[32:35]
    s_add_u32 s7, s13, 64
    v_lshl_add_u32 v37, v1, 4, s7
    v_add_f32 v4, v4, v36
    v_cndmask_b32 v20, v12, v13, s[46:47]
    v_cndmask_b32 v21, v14, v15, s[46:47]
    v_cvt_pk_bf16_f32 v40, v7, v6
    v_cvt_pk_bf16_f32 v41, v5, v4
    ds_write_b64 v69, v[40:41] offset:1536
    v_cvt_pk_bf16_f32 v42, v10, v9
    v_cvt_pk_bf16_f32 v43, v8, v8
    ds_write_b64 v69, v[42:43] offset:1024
    v_cvt_pk_bf16_f32 v44, v13, v20
    v_cvt_pk_bf16_f32 v45, v12, v12
    ds_write_b64 v69, v[44:45] offset:512
    v_cvt_pk_bf16_f32 v46, v15, v21
    v_cvt_pk_bf16_f32 v47, v14, v14
    ds_write_b64 v69, v[46:47] offset:0
    v_cvt_pk_bf16_f32 v48, v15, v15
    v_cvt_pk_bf16_f32 v49, v15, v15
    ds_write_b64 v63, v[48:49] offset:56
    ds_write_b16 v63, v48 offset:54
    v_cvt_pk_bf16_f32 v50, v16, v17
    v_cvt_pk_bf16_f32 v51, v18, v19
    ds_read_b128 v[4:7], v37 offset:0
    ds_read_b64 v[8:9], v37 offset:16
    ds_read_b128 v[12:15], v37 offset:1024
    ds_read_b64 v[16:17], v37 offset:1040
    ds_read_b128 v[20:23], v62 offset:0
    ds_read_b64 v[24:25], v62 offset:16
    ds_write_b16 v67, v50 offset:8832
    ds_write_b16_d16_hi v67, v50 offset:8896
    ds_write_b16 v67, v51 offset:8960
    ds_write_b16_d16_hi v67, v51 offset:9024
    s_waitcnt lgkmcnt(8)
    v_alignbit_b32 v84, v5, v4, 16
    v_alignbit_b32 v85, v6, v5, 16
    v_alignbit_b32 v86, v7, v6, 16
    v_alignbit_b32 v87, v8, v7, 16
    ds_write_b128 v37, v[84:87] offset:2240
    v_pk_mov_b32 v[88:89], v[4:5], v[6:7] op_sel:[1,0]
    v_pk_mov_b32 v[90:91], v[6:7], v[8:9] op_sel:[1,0]
    ds_write_b128 v37, v[88:91] offset:4480
    v_alignbit_b32 v92, v6, v5, 16
    v_alignbit_b32 v93, v7, v6, 16
    v_alignbit_b32 v94, v8, v7, 16
    v_alignbit_b32 v95, v9, v8, 16
    ds_write_b128 v37, v[92:95] offset:6720
    s_waitcnt lgkmcnt(9)
    v_alignbit_b32 v96, v13, v12, 16
    v_alignbit_b32 v97, v14, v13, 16
    v_alignbit_b32 v98, v15, v14, 16
    v_alignbit_b32 v99, v16, v15, 16
    ds_write_b128 v37, v[96:99] offset:3264
    v_pk_mov_b32 v[100:101], v[12:13], v[14:15] op_sel:[1,0]
    v_pk_mov_b32 v[102:103], v[14:15], v[16:17] op_sel:[1,0]
    ds_write_b128 v37, v[100:103] offset:5504
    v_alignbit_b32 v104, v14, v13, 16
    v_alignbit_b32 v105, v15, v14, 16
    v_alignbit_b32 v106, v16, v15, 16
    v_alignbit_b32 v107, v17, v16, 16
    ds_write_b128 v37, v[104:107] offset:7744
    s_waitcnt vmcnt(0)
    v_cmp_ne_u32 vcc, 1, v200
    s_cbranch_vccz KP_a_x
    s_mov_b32 s61, 1048576
KP_a:
    s_sleep 1
KP_a_f:
    buffer_load_dword v200, v201, s[20:23], 0 offen sc1
    s_sub_u32 s61, s61, 1
    s_cbranch_scc1 KP_a_x
    s_waitcnt vmcnt(0)
    v_cmp_ne_u32 vcc, 1, v200
    s_cbranch_vccnz KP_a
KP_a_x:
    buffer_load_dwordx4 v203, s[20:23], s8 offen offset:0 sc1 lds
    buffer_load_dwordx4 v203, s[20:23], s8 offen offset:1024 sc1 lds
    s_waitcnt lgkmcnt(10)
    v_alignbit_b32 v108, v21, v20, 16
    v_alignbit_b32 v109, v22, v21, 16
    v_alignbit_b32 v110, v23, v22, 16
    v_alignbit_b32 v111, v24, v23, 16
    ds_write_b128 v62, v[108:111] offset:2240
    v_pk_mov_b32 v[112:113], v[20:21], v[22:23] op_sel:[1,0]
    v_pk_mov_b32 v[114:115], v[22:23], v[24:25] op_sel:[1,0]
    ds_write_b128 v62, v[112:115] offset:4480
    v_alignbit_b32 v116, v22, v21, 16
    v_alignbit_b32 v117, v23, v22, 16
    v_alignbit_b32 v118, v24, v23, 16
    v_alignbit_b32 v119, v25, v24, 16
    ds_write_b128 v62, v[116:119] offset:6720
    ds_write_b64 v198, v[32:33]
    v_lshlrev_b32 v13, 3, v1
    s_load_dwordx2 s[68:69], s[0:1], 96
    s_mov_b32 s70, 5308416
    s_add_u32 s8, s8, 8192
    s_waitcnt lgkmcnt(0)
    ds_read_b64 v[64:65], v199 offset:2048
    ds_read_b64 v[66:67], v199 offset:2056
    ds_read_b64 v[68:69], v199 offset:1984
    ds_read_b64 v[70:71], v199 offset:1992
    ds_read_b64 v[72:73], v199 offset:1536
    ds_read_b64 v[74:75], v199 offset:1544
    ds_read_b64 v[76:77], v199 offset:1472
    ds_read_b64 v[78:79], v199 offset:1480
    ds_read_b64 v[80:81], v199 offset:1024
    ds_read_b64 v[82:83], v199 offset:1032
    ds_read_b64 v[84:85], v199 offset:960
    ds_read_b64 v[86:87], v199 offset:968
    ds_read_b64 v[88:89], v199 offset:512
    ds_read_b64 v[90:91], v199 offset:520
    ds_read_b64 v[92:93], v199 offset:448
    ds_read_b64 v[94:95], v199 offset:456
    s_cmp_eq_u32 s6, 0
    s_cbranch_scc0 TR_8
    s_call_b64 s[82:83], PG_5
TR_8:
    s_cmp_eq_u32 s6, 1
    s_cbranch_scc0 TR_9
    s_call_b64 s[82:83], PG_8
TR_9:
    s_cmp_eq_u32 s6, 2
    s_cbranch_scc0 TR_10
    s_call_b64 s[82:83], PG_bodyA
TR_10:
    s_cmp_eq_u32 s6, 3
    s_cbranch_scc0 TR_11
    s_call_b64 s[82:83], PG_7
TR_11:
    s_waitcnt vmcnt(0)
    s_barrier
    ds_read_b128 v[96:99], v192 offset:1024
    ds_read_b128 v[100:103], v193 offset:1024
    ds_read_b128 v[104:107], v192 offset:3072
    ds_read_b128 v[108:111], v193 offset:3072
    ds_read_b128 v[112:115], v192 offset:5120
    ds_read_b128 v[116:119], v193 offset:5120
    ds_read_b128 v[120:123], v192 offset:7168
    ds_read_b128 v[124:127], v193 offset:7168
    s_waitcnt lgkmcnt(7)
    v_mfma_f32_16x16x32_bf16 v[16:19], v[64:67], v[96:99], 0
    buffer_load_dword v200, v202, s[20:23], 0 offen sc1
    ds_read_b64 v[128:129], v199 offset:1920
    ds_read_b64 v[130:131], v199 offset:1928
    s_waitcnt lgkmcnt(8)
    v_mfma_f32_16x16x32_bf16 v[16:19], v[68:71], v[100:103], v[16:19]
    ds_read_b128 v[160:163], v194 offset:1024
    s_waitcnt lgkmcnt(8)
    v_mfma_f32_16x16x32_bf16 v[20:23], v[64:67], v[104:107], 0
    ds_read_b64 v[132:133], v199 offset:1856
    v_mfma_f32_16x16x32_bf16 v[20:23], v[72:75], v[96:99], v[20:23]
    ds_read_b64 v[134:135], v199 offset:1864
    s_waitcnt lgkmcnt(8)
    v_mfma_f32_16x16x32_bf16 v[20:23], v[68:71], v[108:111], v[20:23]
    ds_read_b128 v[164:167], v195 offset:1024
    v_mfma_f32_16x16x32_bf16 v[20:23], v[76:79], v[100:103], v[20:23]
    ds_read_b128 v[168:171], v194 offset:3072
    ds_read_b64 v[136:137], v199 offset:1408
    v_mfma_f32_16x16x32_bf16 v[24:27], v[64:67], v[112:115], 0
    ds_read_b64 v[138:139], v199 offset:1416
    v_mfma_f32_16x16x32_bf16 v[24:27], v[72:75], v[104:107], v[24:27]
    ds_read_b128 v[172:175], v195 offset:3072
    v_mfma_f32_16x16x32_bf16 v[24:27], v[80:83], v[96:99], v[24:27]
    s_add_u32 s17, s18, 8192
    s_add_u32 m0, s9, 8192
    ds_read_b64 v[140:141], v199 offset:1344
    s_waitcnt lgkmcnt(11)
    v_mfma_f32_16x16x32_bf16 v[24:27], v[68:71], v[116:119], v[24:27]
    ds_read_b64 v[142:143], v199 offset:1352
    v_mfma_f32_16x16x32_bf16 v[24:27], v[76:79], v[108:111], v[24:27]
    ds_read_b128 v[176:179], v194 offset:5120
    ds_read_b64 v[144:145], v199 offset:896
    v_mfma_f32_16x16x32_bf16 v[24:27], v[84:87], v[100:103], v[24:27]
    ds_read_b64 v[146:147], v199 offset:904
    v_mfma_f32_16x16x32_bf16 v[28:31], v[64:67], v[120:123], 0
    ds_read_b128 v[180:183], v195 offset:5120
    v_mfma_f32_16x16x32_bf16 v[28:31], v[72:75], v[112:115], v[28:31]
    ds_read_b64 v[148:149], v199 offset:832
    v_mfma_f32_16x16x32_bf16 v[28:31], v[80:83], v[104:107], v[28:31]
    ds_read_b64 v[150:151], v199 offset:840
    v_mfma_f32_16x16x32_bf16 v[28:31], v[88:91], v[96:99], v[28:31]
    ds_read_b128 v[184:187], v194 offset:7168
    ds_read_b64 v[152:153], v199 offset:384
    v_mfma_f32_16x16x32_bf16 v[28:31], v[68:71], v[124:127], v[28:31]
    ds_read_b64 v[154:155], v199 offset:392
    v_mfma_f32_16x16x32_bf16 v[28:31], v[76:79], v[116:119], v[28:31]
    ds_read_b128 v[188:191], v195 offset:7168
    v_mfma_f32_16x16x32_bf16 v[28:31], v[84:87], v[108:111], v[28:31]
    ds_read_b64 v[156:157], v199 offset:320
    v_mfma_f32_16x16x32_bf16 v[28:31], v[92:95], v[100:103], v[28:31]
    ds_read_b64 v[158:159], v199 offset:328
    s_waitcnt lgkmcnt(9)
    v_mfma_f32_16x16x32_bf16 v[16:19], v[128:131], v[160:163], v[16:19]
    ds_read_b64 v[64:65], v199 offset:1792
    ds_read_b64 v[66:67], v199 offset:1800
    v_mfma_f32_16x16x32_bf16 v[16:19], v[132:135], v[164:167], v[16:19]
    ds_read_b128 v[96:99], v192 offset:0
    v_mfma_f32_16x16x32_bf16 v[20:23], v[128:131], v[168:171], v[20:23]
    buffer_store_dwordx4 v[220:223], v203, s[20:23], s17 offen offset:0 sc1
    ds_read_b64 v[68:69], v199 offset:1728
    v_mfma_f32_16x16x32_bf16 v[20:23], v[136:139], v[160:163], v[20:23]
    ds_read_b64 v[70:71], v199 offset:1736
    v_mfma_f32_16x16x32_bf16 v[20:23], v[132:135], v[172:175], v[20:23]
    ds_read_b128 v[100:103], v193 offset:0
    v_mfma_f32_16x16x32_bf16 v[20:23], v[140:143], v[164:167], v[20:23]
    ds_read_b128 v[104:107], v192 offset:2048
    ds_read_b64 v[72:73], v199 offset:1280
    v_mfma_f32_16x16x32_bf16 v[24:27], v[128:131], v[176:179], v[24:27]
    ds_read_b64 v[74:75], v199 offset:1288
    v_mfma_f32_16x16x32_bf16 v[24:27], v[136:139], v[168:171], v[24:27]
    ds_read_b128 v[108:111], v193 offset:2048
    v_mfma_f32_16x16x32_bf16 v[24:27], v[144:147], v[160:163], v[24:27]
    buffer_store_dwordx4 v[220:223], v203, s[20:23], s17 offen offset:1024 sc1
    ds_read_b64 v[76:77], v199 offset:1216
    s_waitcnt lgkmcnt(13)
    v_mfma_f32_16x16x32_bf16 v[24:27], v[132:135], v[180:183], v[24:27]
    ds_read_b64 v[78:79], v199 offset:1224
    v_mfma_f32_16x16x32_bf16 v[24:27], v[140:143], v[172:175], v[24:27]
    buffer_store_dword v197, v196, s[20:23], s16 offen sc1
    ds_read_b128 v[112:115], v192 offset:4096
    ds_read_b64 v[80:81], v199 offset:768
    v_mfma_f32_16x16x32_bf16 v[24:27], v[148:151], v[164:167], v[24:27]
    ds_read_b64 v[82:83], v199 offset:776
    v_mfma_f32_16x16x32_bf16 v[28:31], v[128:131], v[184:187], v[28:31]
    ds_read_b128 v[116:119], v193 offset:4096
    v_mfma_f32_16x16x32_bf16 v[28:31], v[136:139], v[176:179], v[28:31]
    ds_read_b64 v[84:85], v199 offset:704
    v_mfma_f32_16x16x32_bf16 v[28:31], v[144:147], v[168:171], v[28:31]
    ds_read_b64 v[86:87], v199 offset:712
    v_mfma_f32_16x16x32_bf16 v[28:31], v[152:155], v[160:163], v[28:31]
    ds_read_b128 v[120:123], v192 offset:6144
    ds_read_b64 v[88:89], v199 offset:256
    v_mfma_f32_16x16x32_bf16 v[28:31], v[132:135], v[188:191], v[28:31]
    ds_read_b64 v[90:91], v199 offset:264
    v_mfma_f32_16x16x32_bf16 v[28:31], v[140:143], v[180:183], v[28:31]
    ds_read_b128 v[124:127], v193 offset:6144
    v_mfma_f32_16x16x32_bf16 v[28:31], v[148:151], v[172:175], v[28:31]
    ds_read_b64 v[92:93], v199 offset:192
    s_waitcnt lgkmcnt(10)
    v_mfma_f32_16x16x32_bf16 v[28:31], v[156:159], v[164:167], v[28:31]
    ds_read_b64 v[94:95], v199 offset:200
    v_mfma_f32_16x16x32_bf16 v[16:19], v[64:67], v[96:99], v[16:19]
    ds_read_b64 v[128:129], v199 offset:1664
    ds_read_b64 v[130:131], v199 offset:1672
    v_mfma_f32_16x16x32_bf16 v[16:19], v[68:71], v[100:103], v[16:19]
    ds_read_b128 v[160:163], v194 offset:0
    v_mfma_f32_16x16x32_bf16 v[20:23], v[64:67], v[104:107], v[20:23]
    ds_read_b64 v[132:133], v199 offset:1600
    v_mfma_f32_16x16x32_bf16 v[20:23], v[72:75], v[96:99], v[20:23]
    ds_read_b64 v[134:135], v199 offset:1608
    v_mfma_f32_16x16x32_bf16 v[20:23], v[68:71], v[108:111], v[20:23]
    ds_read_b128 v[164:167], v195 offset:0
    v_mfma_f32_16x16x32_bf16 v[20:23], v[76:79], v[100:103], v[20:23]
    ds_read_b128 v[168:171], v194 offset:2048
    ds_read_b64 v[136:137], v199 offset:1152
    v_mfma_f32_16x16x32_bf16 v[24:27], v[64:67], v[112:115], v[24:27]
    ds_read_b64 v[138:139], v199 offset:1160
    v_mfma_f32_16x16x32_bf16 v[24:27], v[72:75], v[104:107], v[24:27]
    ds_read_b128 v[172:175], v195 offset:2048
    s_waitcnt lgkmcnt(12)
    v_mfma_f32_16x16x32_bf16 v[24:27], v[80:83], v[96:99], v[24:27]
    ds_read_b64 v[140:141], v199 offset:1088
    v_mfma_f32_16x16x32_bf16 v[24:27], v[68:71], v[116:119], v[24:27]
    ds_read_b64 v[142:143], v199 offset:1096
    v_mfma_f32_16x16x32_bf16 v[24:27], v[76:79], v[108:111], v[24:27]
    s_branch PG_10_go
PG_10_prev_end:
    .p2align 12
PG_10:
    s_setpc_b64 s[82:83]
PG_10_go:
    ds_read_b128 v[176:179], v194 offset:4096
    ds_read_b64 v[144:145], v199 offset:640
    v_mfma_f32_16x16x32_bf16 v[24:27], v[84:87], v[100:103], v[24:27]
    ds_read_b64 v[146:147], v199 offset:648
    v_mfma_f32_16x16x32_bf16 v[28:31], v[64:67], v[120:123], v[28:31]
    ds_read_b128 v[180:183], v195 offset:4096
    v_mfma_f32_16x16x32_bf16 v[28:31], v[72:75], v[112:115], v[28:31]
    ds_read_b64 v[148:149], v199 offset:576
    v_mfma_f32_16x16x32_bf16 v[28:31], v[80:83], v[104:107], v[28:31]
    ds_read_b64 v[150:151], v199 offset:584
    v_mfma_f32_16x16x32_bf16 v[28:31], v[88:91], v[96:99], v[28:31]
    ds_read_b128 v[184:187], v194 offset:6144
    ds_read_b64 v[152:153], v199 offset:128
    v_mfma_f32_16x16x32_bf16 v[28:31], v[68:71], v[124:127], v[28:31]
    ds_read_b64 v[154:155], v199 offset:136
    v_mfma_f32_16x16x32_bf16 v[28:31], v[76:79], v[116:119], v[28:31]
    ds_read_b128 v[188:191], v195 offset:6144
    v_mfma_f32_16x16x32_bf16 v[28:31], v[84:87], v[108:111], v[28:31]
    ds_read_b64 v[156:157], v199 offset:64
    s_waitcnt lgkmcnt(10)
    v_mfma_f32_16x16x32_bf16 v[28:31], v[92:95], v[100:103], v[28:31]
    ds_read_b64 v[158:159], v199 offset:72
    s_waitcnt vmcnt(3)
    v_cmp_ne_u32 vcc, 1, v200
    s_cbranch_vccz KP_a2_x
    s_mov_b32 s61, 1048576
    s_branch KP_a2_f
KP_a2:
    s_sleep 1
KP_a2_f:
    buffer_load_dword v200, v202, s[20:23], 0 offen sc1
    s_sub_u32 s61, s61, 1
    s_cbranch_scc1 KP_a2_x
    s_waitcnt vmcnt(0)
    v_cmp_ne_u32 vcc, 1, v200
    s_cbranch_vccnz KP_a2
KP_a2_x:
    v_mfma_f32_16x16x32_bf16 v[16:19], v[128:131], v[160:163], v[16:19]
    buffer_load_dwordx4 v203, s[20:23], s8 offen offset:0 sc1 lds
    ds_read_b128 v[96:99], v193 offset:1024
    v_mfma_f32_16x16x32_bf16 v[16:19], v[132:135], v[164:167], v[16:19]
    ds_read_b128 v[100:103], v192 offset:1024
    v_mfma_f32_16x16x32_bf16 v[20:23], v[128:131], v[168:171], v[20:23]
    ds_read_b128 v[104:107], v193 offset:3072
    v_mfma_f32_16x16x32_bf16 v[20:23], v[136:139], v[160:163], v[20:23]
    buffer_load_dwordx4 v203, s[20:23], s8 offen offset:1024 sc1 lds
    ds_read_b128 v[108:111], v192 offset:3072
    v_mfma_f32_16x16x32_bf16 v[20:23], v[132:135], v[172:175], v[20:23]
    ds_read_b128 v[112:115], v193 offset:5120
    v_mfma_f32_16x16x32_bf16 v[20:23], v[140:143], v[164:167], v[20:23]
    ds_read_b128 v[116:119], v192 offset:5120
    v_mfma_f32_16x16x32_bf16 v[24:27], v[128:131], v[176:179], v[24:27]
    ds_read_b128 v[120:123], v193 offset:7168
    v_mfma_f32_16x16x32_bf16 v[24:27], v[136:139], v[168:171], v[24:27]
    v_cvt_pk_bf16_f32 v48, v16, v17
    v_cvt_pk_bf16_f32 v49, v18, v19
    ds_write_b64 v204, v[48:49] offset:0
    ds_read_b128 v[124:127], v192 offset:7168
    s_waitcnt lgkmcnt(11)
    v_mfma_f32_16x16x32_bf16 v[24:27], v[144:147], v[160:163], v[24:27]
    ds_read_b64 v[64:65], v199 offset:0
    v_mfma_f32_16x16x32_bf16 v[24:27], v[132:135], v[180:183], v[24:27]
    v_mfma_f32_16x16x32_bf16 v[24:27], v[140:143], v[172:175], v[24:27]
    ds_read_b64 v[66:67], v199 offset:8
    v_mfma_f32_16x16x32_bf16 v[24:27], v[148:151], v[164:167], v[24:27]
    v_cvt_pk_bf16_f32 v50, v20, v21
    v_cvt_pk_bf16_f32 v51, v22, v23
    ds_write_b64 v204, v[50:51] offset:576
    ds_read2_b32 v[68:69], v2 offset0:3 offset1:2
    v_mfma_f32_16x16x32_bf16 v[28:31], v[128:131], v[184:187], v[28:31]
    ds_read2_b32 v[70:71], v2 offset0:1 offset1:0
    v_mfma_f32_16x16x32_bf16 v[28:31], v[136:139], v[176:179], v[28:31]
    ds_read2_b32 v[72:73], v2 offset0:19 offset1:18
    v_mfma_f32_16x16x32_bf16 v[28:31], v[144:147], v[168:171], v[28:31]
    ds_read2_b32 v[74:75], v2 offset0:17 offset1:16
    v_mfma_f32_16x16x32_bf16 v[28:31], v[152:155], v[160:163], v[28:31]
    ds_read2_b32 v[76:77], v2 offset0:35 offset1:34
    v_mfma_f32_16x16x32_bf16 v[28:31], v[132:135], v[188:191], v[28:31]
    ds_read2_b32 v[78:79], v2 offset0:33 offset1:32
    v_mfma_f32_16x16x32_bf16 v[28:31], v[140:143], v[180:183], v[28:31]
    v_cvt_pk_bf16_f32 v52, v24, v25
    v_cvt_pk_bf16_f32 v53, v26, v27
    ds_write_b64 v204, v[52:53] offset:1152
    ds_read2_b32 v[80:81], v2 offset0:51 offset1:50
    v_mfma_f32_16x16x32_bf16 v[28:31], v[148:151], v[172:175], v[28:31]
    ds_read2_b32 v[82:83], v2 offset0:49 offset1:48
    s_waitcnt lgkmcnt(14)
    v_mfma_f32_16x16x32_bf16 v[28:31], v[156:159], v[164:167], v[28:31]
    v_mfma_f32_16x16x32_bf16 v[252:255], v[96:99], v[232:235], 0
    ds_read_b64 v[128:129], v199 offset:1536
    v_mfma_f32_16x16x32_bf16 v[252:255], v[100:103], v[228:231], v[252:255]
    v_mfma_f32_16x16x32_bf16 v[236:239], v[100:103], v[224:227], 0
    ds_read_b64 v[130:131], v199 offset:1544
    v_mfma_f32_16x16x32_bf16 v[84:87], v[104:107], v[232:235], 0
    v_mfma_f32_16x16x32_bf16 v[84:87], v[108:111], v[228:231], v[84:87]
    ds_read_b128 v[160:163], v192 offset:7168
    v_mfma_f32_16x16x32_bf16 v[240:243], v[108:111], v[224:227], 0
    v_cvt_pk_bf16_f32 v54, v28, v29
    v_cvt_pk_bf16_f32 v55, v30, v31
    ds_write_b64 v204, v[54:55] offset:1728
    v_mfma_f32_16x16x32_bf16 v[88:91], v[112:115], v[232:235], 0
    v_mfma_f32_16x16x32_bf16 v[88:91], v[116:119], v[228:231], v[88:91]
    ds_read_b64 v[132:133], v199 offset:1024
    v_mfma_f32_16x16x32_bf16 v[244:247], v[116:119], v[224:227], 0
    s_waitcnt lgkmcnt(1)
    s_barrier
    ds_read_b64_tr_b16 v[4:5], v206 offset:0
    ds_read_b64_tr_b16 v[6:7], v206 offset:32
    v_mfma_f32_16x16x32_bf16 v[92:95], v[120:123], v[232:235], 0
    ds_read_b64_tr_b16 v[8:9], v206 offset:64
    ds_read_b64_tr_b16 v[10:11], v206 offset:96
    ds_read_b64 v[134:135], v199 offset:1032
    v_mfma_f32_16x16x32_bf16 v[92:95], v[124:127], v[228:231], v[92:95]
    v_cvt_pk_bf16_f32 v236, v236, v252
    v_cvt_pk_bf16_f32 v237, v237, v253
    v_mfma_f32_16x16x32_bf16 v[248:251], v[124:127], v[224:227], 0
    v_cvt_pk_bf16_f32 v238, v238, v254
    v_cvt_pk_bf16_f32 v239, v239, v255
    ds_read_b128 v[164:167], v192 offset:5120
    v_mfma_f32_16x16x32_bf16 v[32:35], v[64:67], v[100:103], 0
    v_cvt_pk_bf16_f32 v240, v240, v84
    v_cvt_pk_bf16_f32 v241, v241, v85
    v_mfma_f32_16x16x32_bf16 v[36:39], v[64:67], v[108:111], 0
    v_cvt_pk_bf16_f32 v242, v242, v86
    v_cvt_pk_bf16_f32 v243, v243, v87
    v_mfma_f32_16x16x32_bf16 v[40:43], v[64:67], v[116:119], 0
    s_waitcnt lgkmcnt(5)
    buffer_store_dwordx2 v[4:5], v13, s[20:23], s18 offen offset:0 sc1
    ds_read_b64 v[136:137], v199 offset:512
    v_mfma_f32_16x16x32_bf16 v[44:47], v[64:67], v[124:127], 0
    v_cvt_pk_bf16_f32 v244, v244, v88
    v_cvt_pk_bf16_f32 v245, v245, v89
    v_mfma_f32_16x16x32_bf16 v[32:35], v[236:239], v[68:71], v[32:35]
    v_cvt_pk_bf16_f32 v246, v246, v90
    v_cvt_pk_bf16_f32 v247, v247, v91
    ds_read_b64 v[138:139], v199 offset:520
    v_mfma_f32_16x16x32_bf16 v[36:39], v[236:239], v[72:75], v[36:39]
    s_waitcnt lgkmcnt(6)
    buffer_store_dwordx2 v[6:7], v13, s[20:23], s18 offen offset:512 sc1
    v_mfma_f32_16x16x32_bf16 v[36:39], v[240:243], v[68:71], v[36:39]
    v_cvt_pk_bf16_f32 v248, v248, v92
    v_cvt_pk_bf16_f32 v249, v249, v93
    ds_read_b128 v[168:171], v192 offset:3072
    v_mfma_f32_16x16x32_bf16 v[40:43], v[236:239], v[76:79], v[40:43]
    v_cvt_pk_bf16_f32 v250, v250, v94
    v_cvt_pk_bf16_f32 v251, v251, v95
    v_mfma_f32_16x16x32_bf16 v[40:43], v[240:243], v[72:75], v[40:43]
    s_waitcnt lgkmcnt(6)
    buffer_store_dwordx2 v[8:9], v13, s[20:23], s18 offen offset:1024 sc1
    v_mfma_f32_16x16x32_bf16 v[40:43], v[244:247], v[68:71], v[40:43]
    ds_read_b64 v[140:141], v199 offset:2048
    v_mfma_f32_16x16x32_bf16 v[44:47], v[236:239], v[80:83], v[44:47]
    v_mfma_f32_16x16x32_bf16 v[44:47], v[240:243], v[76:79], v[44:47]
    s_waitcnt lgkmcnt(6)
    buffer_store_dwordx2 v[10:11], v13, s[20:23], s18 offen offset:1536 sc1
    s_mov_b32 s18, s17
    s_waitcnt vmcnt(4)
    s_barrier
    ds_read_b64 v[142:143], v199 offset:2056
    v_mfma_f32_16x16x32_bf16 v[44:47], v[244:247], v[72:75], v[44:47]
    ds_read_b128 v[172:175], v192 offset:9216
    ds_read_b128 v[176:179], v192 offset:11264
    v_mfma_f32_16x16x32_bf16 v[44:47], v[248:251], v[68:71], v[44:47]
    ds_read_b128 v[180:183], v192 offset:13312
    ds_read_b128 v[184:187], v192 offset:15360
    v_mfma_f32_16x16x32_bf16 v[32:35], v[128:131], v[160:163], v[32:35]
    s_add_u32 m0, s31, 0
    ds_read_b64 v[64:65], v199 offset:1984
    s_waitcnt lgkmcnt(8)
    v_mfma_f32_16x16x32_bf16 v[32:35], v[132:135], v[164:167], v[32:35]
    ds_read_b64 v[66:67], v199 offset:1992
    s_waitcnt lgkmcnt(8)
    v_mfma_f32_16x16x32_bf16 v[32:35], v[136:139], v[168:171], v[32:35]
    ds_read_b128 v[96:99], v193 offset:9216
    v_mfma_f32_16x16x32_bf16 v[36:39], v[132:135], v[160:163], v[36:39]
    ds_read_b64 v[68:69], v199 offset:1472
    v_mfma_f32_16x16x32_bf16 v[36:39], v[136:139], v[164:167], v[36:39]
    buffer_load_dwordx4 v212, s[24:27], s67 offen offset:0 sc1 lds
    ds_read_b64 v[70:71], v199 offset:1480
    v_mfma_f32_16x16x32_bf16 v[40:43], v[136:139], v[160:163], v[40:43]
    ds_read_b128 v[100:103], v193 offset:7168
    s_waitcnt lgkmcnt(8)
    v_mfma_f32_16x16x32_bf16 v[32:35], v[140:143], v[172:175], v[32:35]
    ds_read_b64 v[72:73], v199 offset:960
    v_mfma_f32_16x16x32_bf16 v[36:39], v[140:143], v[176:179], v[36:39]
    ds_read_b64 v[74:75], v199 offset:968
    v_mfma_f32_16x16x32_bf16 v[36:39], v[128:131], v[172:175], v[36:39]
    ds_read_b128 v[104:107], v193 offset:5120
    s_waitcnt lgkmcnt(8)
    v_mfma_f32_16x16x32_bf16 v[40:43], v[140:143], v[180:183], v[40:43]
    buffer_load_dwordx4 v213, s[24:27], s67 offen offset:1024 sc1 lds
    ds_read_b64 v[76:77], v199 offset:448
    v_mfma_f32_16x16x32_bf16 v[40:43], v[128:131], v[176:179], v[40:43]
    ds_read_b64 v[78:79], v199 offset:456
    v_mfma_f32_16x16x32_bf16 v[40:43], v[132:135], v[172:175], v[40:43]
    ds_read_b128 v[108:111], v193 offset:3072
    v_mfma_f32_16x16x32_bf16 v[44:47], v[140:143], v[184:187], v[44:47]
    ds_read_b128 v[112:115], v193 offset:11264
    v_mfma_f32_16x16x32_bf16 v[44:47], v[128:131], v[180:183], v[44:47]
    buffer_load_dwordx4 v214, s[24:27], s67 offen offset:2048 sc1 lds
    ds_read_b128 v[116:119], v193 offset:13312
    v_mfma_f32_16x16x32_bf16 v[44:47], v[132:135], v[176:179], v[44:47]
    ds_read_b128 v[120:123], v193 offset:15360
    v_mfma_f32_16x16x32_bf16 v[44:47], v[136:139], v[172:175], v[44:47]
    s_waitcnt lgkmcnt(8)
    v_mfma_f32_16x16x32_bf16 v[32:35], v[64:67], v[96:99], v[32:35]
    ds_read_b64 v[128:129], v199 offset:1920
    v_mfma_f32_16x16x32_bf16 v[32:35], v[68:71], v[100:103], v[32:35]
    ds_read_b64 v[130:131], v199 offset:1928
    s_waitcnt lgkmcnt(8)
    v_mfma_f32_16x16x32_bf16 v[32:35], v[72:75], v[104:107], v[32:35]
    buffer_load_dwordx4 v215, s[24:27], s67 offen offset:3072 sc1 lds
    s_add_u32 m0, m0, 4096
    s_add_u32 s67, s67, 294912
    ds_read_b128 v[160:163], v194 offset:9216
    s_waitcnt lgkmcnt(6)
    v_mfma_f32_16x16x32_bf16 v[32:35], v[76:79], v[108:111], v[32:35]
    ds_read_b64 v[132:133], v199 offset:1408
    s_waitcnt lgkmcnt(6)
    v_mfma_f32_16x16x32_bf16 v[36:39], v[64:67], v[112:115], v[36:39]
    ds_read_b64 v[134:135], v199 offset:1416
    v_mfma_f32_16x16x32_bf16 v[36:39], v[68:71], v[96:99], v[36:39]
    ds_read_b128 v[164:167], v194 offset:7168
    v_mfma_f32_16x16x32_bf16 v[36:39], v[72:75], v[100:103], v[36:39]
    ds_read_b64 v[136:137], v199 offset:896
    v_mfma_f32_16x16x32_bf16 v[36:39], v[76:79], v[104:107], v[36:39]
    buffer_load_dwordx4 v212, s[24:27], s67 offen offset:0 sc1 lds
    ds_read_b64 v[138:139], v199 offset:904
    s_waitcnt lgkmcnt(8)
    v_mfma_f32_16x16x32_bf16 v[40:43], v[64:67], v[116:119], v[40:43]
    ds_read_b128 v[168:171], v194 offset:5120
    v_mfma_f32_16x16x32_bf16 v[40:43], v[68:71], v[112:115], v[40:43]
    ds_read_b64 v[140:141], v199 offset:384
    v_mfma_f32_16x16x32_bf16 v[40:43], v[72:75], v[96:99], v[40:43]
    ds_read_b64 v[142:143], v199 offset:392
    v_mfma_f32_16x16x32_bf16 v[40:43], v[76:79], v[100:103], v[40:43]
    buffer_load_dwordx4 v213, s[24:27], s67 offen offset:1024 sc1 lds
    ds_read_b128 v[172:175], v194 offset:3072
    v_mfma_f32_16x16x32_bf16 v[44:47], v[64:67], v[120:123], v[44:47]
    ds_read_b128 v[176:179], v194 offset:11264
    v_mfma_f32_16x16x32_bf16 v[44:47], v[68:71], v[116:119], v[44:47]
    ds_read_b128 v[180:183], v194 offset:13312
    v_mfma_f32_16x16x32_bf16 v[44:47], v[72:75], v[112:115], v[44:47]
    ds_read_b128 v[184:187], v194 offset:15360
    v_mfma_f32_16x16x32_bf16 v[44:47], v[76:79], v[96:99], v[44:47]
    s_waitcnt lgkmcnt(8)
    v_mfma_f32_16x16x32_bf16 v[32:35], v[128:131], v[160:163], v[32:35]
    buffer_load_dwordx4 v214, s[24:27], s67 offen offset:2048 sc1 lds
    ds_read_b64 v[64:65], v199 offset:1856
    v_mfma_f32_16x16x32_bf16 v[32:35], v[132:135], v[164:167], v[32:35]
    ds_read_b64 v[66:67], v199 offset:1864
    s_waitcnt lgkmcnt(8)
    v_mfma_f32_16x16x32_bf16 v[32:35], v[136:139], v[168:171], v[32:35]
    ds_read_b128 v[96:99], v195 offset:9216
    s_waitcnt lgkmcnt(6)
    v_mfma_f32_16x16x32_bf16 v[32:35], v[140:143], v[172:175], v[32:35]
    ds_read_b64 v[68:69], v199 offset:1344
    s_waitcnt lgkmcnt(6)
    v_mfma_f32_16x16x32_bf16 v[36:39], v[128:131], v[176:179], v[36:39]
    buffer_load_dwordx4 v215, s[24:27], s67 offen offset:3072 sc1 lds
    s_add_u32 s67, s67, 294912
    ds_read_b64 v[70:71], v199 offset:1352
    v_mfma_f32_16x16x32_bf16 v[36:39], v[132:135], v[160:163], v[36:39]
    ds_read_b128 v[100:103], v195 offset:7168
    v_mfma_f32_16x16x32_bf16 v[36:39], v[136:139], v[164:167], v[36:39]
    ds_read_b64 v[72:73], v199 offset:832
    v_mfma_f32_16x16x32_bf16 v[36:39], v[140:143], v[168:171], v[36:39]
    ds_read_b64 v[74:75], v199 offset:840
    s_waitcnt lgkmcnt(8)
    v_mfma_f32_16x16x32_bf16 v[40:43], v[128:131], v[180:183], v[40:43]
    ds_read_b128 v[104:107], v195 offset:5120
    v_mfma_f32_16x16x32_bf16 v[40:43], v[132:135], v[176:179], v[40:43]
    s_add_u32 m0, s31, 32768
    ds_read_b64 v[76:77], v199 offset:320
    v_mfma_f32_16x16x32_bf16 v[40:43], v[136:139], v[160:163], v[40:43]
    ds_read_b64 v[78:79], v199 offset:328
    v_mfma_f32_16x16x32_bf16 v[40:43], v[140:143], v[164:167], v[40:43]
    ds_read_b128 v[108:111], v195 offset:3072
    v_mfma_f32_16x16x32_bf16 v[44:47], v[128:131], v[184:187], v[44:47]
    ds_read_b128 v[112:115], v195 offset:11264
    v_mfma_f32_16x16x32_bf16 v[44:47], v[132:135], v[180:183], v[44:47]
    ds_read_b128 v[116:119], v195 offset:13312
    v_mfma_f32_16x16x32_bf16 v[44:47], v[136:139], v[176:179], v[44:47]
    buffer_load_dwordx4 v212, s[24:27], s67 offen offset:0 sc1 lds
    ds_read_b128 v[120:123], v195 offset:15360
    v_mfma_f32_16x16x32_bf16 v[44:47], v[140:143], v[160:163], v[44:47]
    s_waitcnt lgkmcnt(8)
    v_mfma_f32_16x16x32_bf16 v[32:35], v[64:67], v[96:99], v[32:35]
    ds_read_b64 v[128:129], v199 offset:1792
    v_mfma_f32_16x16x32_bf16 v[32:35], v[68:71], v[100:103], v[32:35]
    ds_read_b64 v[130:131], v199 offset:1800
    s_waitcnt lgkmcnt(8)
    v_mfma_f32_16x16x32_bf16 v[32:35], v[72:75], v[104:107], v[32:35]
    buffer_load_dwordx4 v213, s[24:27], s67 offen offset:1024 sc1 lds
    ds_read_b128 v[160:163], v192 offset:8192
    s_waitcnt lgkmcnt(6)
    v_mfma_f32_16x16x32_bf16 v[32:35], v[76:79], v[108:111], v[32:35]
    ds_read_b64 v[132:133], v199 offset:1280
    s_waitcnt lgkmcnt(6)
    v_mfma_f32_16x16x32_bf16 v[36:39], v[64:67], v[112:115], v[36:39]
    ds_read_b64 v[134:135], v199 offset:1288
    v_mfma_f32_16x16x32_bf16 v[36:39], v[68:71], v[96:99], v[36:39]
    ds_read_b128 v[164:167], v192 offset:6144
    v_mfma_f32_16x16x32_bf16 v[36:39], v[72:75], v[100:103], v[36:39]
    ds_read_b64 v[136:137], v199 offset:768
    v_mfma_f32_16x16x32_bf16 v[36:39], v[76:79], v[104:107], v[36:39]
    buffer_load_dwordx4 v214, s[24:27], s67 offen offset:2048 sc1 lds
    ds_read_b64 v[138:139], v199 offset:776
    s_waitcnt lgkmcnt(8)
    v_mfma_f32_16x16x32_bf16 v[40:43], v[64:67], v[116:119], v[40:43]
    ds_read_b128 v[168:171], v192 offset:4096
    v_mfma_f32_16x16x32_bf16 v[40:43], v[68:71], v[112:115], v[40:43]
    ds_read_b64 v[140:141], v199 offset:256
    v_mfma_f32_16x16x32_bf16 v[40:43], v[72:75], v[96:99], v[40:43]
    ds_read_b64 v[142:143], v199 offset:264
    v_mfma_f32_16x16x32_bf16 v[40:43], v[76:79], v[100:103], v[40:43]
    ds_read_b128 v[172:175], v192 offset:2048
    v_mfma_f32_16x16x32_bf16 v[44:47], v[64:67], v[120:123], v[44:47]
    buffer_load_dwordx4 v215, s[24:27], s67 offen offset:3072 sc1 lds
    s_add_u32 m0, m0, 4096
    s_add_u32 s67, s67, 294912
    ds_read_b128 v[176:179], v192 offset:10240
    v_mfma_f32_16x16x32_bf16 v[44:47], v[68:71], v[116:119], v[44:47]
    ds_read_b128 v[180:183], v192 offset:12288
    v_mfma_f32_16x16x32_bf16 v[44:47], v[72:75], v[112:115], v[44:47]
    ds_read_b128 v[184:187], v192 offset:14336
    v_mfma_f32_16x16x32_bf16 v[44:47], v[76:79], v[96:99], v[44:47]
    s_waitcnt lgkmcnt(8)
    v_mfma_f32_16x16x32_bf16 v[32:35], v[128:131], v[160:163], v[32:35]
    buffer_load_dwordx4 v212, s[24:27], s67 offen offset:0 sc1 lds
    ds_read_b64 v[64:65], v199 offset:1728
    v_mfma_f32_16x16x32_bf16 v[32:35], v[132:135], v[164:167], v[32:35]
    ds_read_b64 v[66:67], v199 offset:1736
    s_waitcnt lgkmcnt(8)
    v_mfma_f32_16x16x32_bf16 v[32:35], v[136:139], v[168:171], v[32:35]
    ds_read_b128 v[96:99], v193 offset:8192
    s_waitcnt lgkmcnt(6)
    v_mfma_f32_16x16x32_bf16 v[32:35], v[140:143], v[172:175], v[32:35]
    ds_read_b64 v[68:69], v199 offset:1216
    s_waitcnt lgkmcnt(6)
    v_mfma_f32_16x16x32_bf16 v[36:39], v[128:131], v[176:179], v[36:39]
    ds_read_b64 v[70:71], v199 offset:1224
    v_mfma_f32_16x16x32_bf16 v[36:39], v[132:135], v[160:163], v[36:39]
    buffer_load_dwordx4 v213, s[24:27], s67 offen offset:1024 sc1 lds
    ds_read_b128 v[100:103], v193 offset:6144
    v_mfma_f32_16x16x32_bf16 v[36:39], v[136:139], v[164:167], v[36:39]
    ds_read_b64 v[72:73], v199 offset:704
    v_mfma_f32_16x16x32_bf16 v[36:39], v[140:143], v[168:171], v[36:39]
    ds_read_b64 v[74:75], v199 offset:712
    s_waitcnt lgkmcnt(8)
    v_mfma_f32_16x16x32_bf16 v[40:43], v[128:131], v[180:183], v[40:43]
    ds_read_b128 v[104:107], v193 offset:4096
    v_mfma_f32_16x16x32_bf16 v[40:43], v[132:135], v[176:179], v[40:43]
    buffer_load_dwordx4 v214, s[24:27], s67 offen offset:2048 sc1 lds
    ds_read_b64 v[76:77], v199 offset:192
    v_mfma_f32_16x16x32_bf16 v[40:43], v[136:139], v[160:163], v[40:43]
    ds_read_b64 v[78:79], v199 offset:200
    v_mfma_f32_16x16x32_bf16 v[40:43], v[140:143], v[164:167], v[40:43]
    ds_read_b128 v[108:111], v193 offset:2048
    v_mfma_f32_16x16x32_bf16 v[44:47], v[128:131], v[184:187], v[44:47]
    ds_read_b128 v[112:115], v193 offset:10240
    v_mfma_f32_16x16x32_bf16 v[44:47], v[132:135], v[180:183], v[44:47]
    ds_read_b128 v[116:119], v193 offset:12288
    v_mfma_f32_16x16x32_bf16 v[44:47], v[136:139], v[176:179], v[44:47]
    buffer_load_dwordx4 v215, s[24:27], s67 offen offset:3072 sc1 lds
    s_add_u32 s67, s67, 294912
    ds_read_b128 v[120:123], v193 offset:14336
    v_mfma_f32_16x16x32_bf16 v[44:47], v[140:143], v[160:163], v[44:47]
    s_waitcnt lgkmcnt(8)
    v_mfma_f32_16x16x32_bf16 v[32:35], v[64:67], v[96:99], v[32:35]
    ds_read_b64 v[128:129], v199 offset:1664
    v_mfma_f32_16x16x32_bf16 v[32:35], v[68:71], v[100:103], v[32:35]
    ds_read_b64 v[130:131], v199 offset:1672
    s_waitcnt lgkmcnt(8)
    v_mfma_f32_16x16x32_bf16 v[32:35], v[72:75], v[104:107], v[32:35]
    ds_read_b128 v[160:163], v194 offset:8192
    s_waitcnt lgkmcnt(6)
    v_mfma_f32_16x16x32_bf16 v[32:35], v[76:79], v[108:111], v[32:35]
    s_add_u32 m0, s31, 65536
    ds_read_b64 v[132:133], v199 offset:1152
    s_waitcnt lgkmcnt(6)
    v_mfma_f32_16x16x32_bf16 v[36:39], v[64:67], v[112:115], v[36:39]
    ds_read_b64 v[134:135], v199 offset:1160
    v_mfma_f32_16x16x32_bf16 v[36:39], v[68:71], v[96:99], v[36:39]
    ds_read_b128 v[164:167], v194 offset:6144
    v_mfma_f32_16x16x32_bf16 v[36:39], v[72:75], v[100:103], v[36:39]
    ds_read_b64 v[136:137], v199 offset:640
    v_mfma_f32_16x16x32_bf16 v[36:39], v[76:79], v[104:107], v[36:39]
    buffer_load_dwordx4 v212, s[24:27], s67 offen offset:0 sc1 lds
    ds_read_b64 v[138:139], v199 offset:648
    s_waitcnt lgkmcnt(8)
    v_mfma_f32_16x16x32_bf16 v[40:43], v[64:67], v[116:119], v[40:43]
    buffer_store_dword v197, v196, s[20:23], 0 offen sc1
    ds_read_b128 v[168:171], v194 offset:4096
    v_mfma_f32_16x16x32_bf16 v[40:43], v[68:71], v[112:115], v[40:43]
    ds_read_b64 v[140:141], v199 offset:128
    v_mfma_f32_16x16x32_bf16 v[40:43], v[72:75], v[96:99], v[40:43]
    ds_read_b64 v[142:143], v199 offset:136
    v_mfma_f32_16x16x32_bf16 v[40:43], v[76:79], v[100:103], v[40:43]
    ds_read_b128 v[172:175], v194 offset:2048
    v_mfma_f32_16x16x32_bf16 v[44:47], v[64:67], v[120:123], v[44:47]
    buffer_load_dwordx4 v213, s[24:27], s67 offen offset:1024 sc1 lds
    ds_read_b128 v[176:179], v194 offset:10240
    v_mfma_f32_16x16x32_bf16 v[44:47], v[68:71], v[116:119], v[44:47]
    ds_read_b128 v[180:183], v194 offset:12288
    v_mfma_f32_16x16x32_bf16 v[44:47], v[72:75], v[112:115], v[44:47]
    ds_read_b128 v[184:187], v194 offset:14336
    v_mfma_f32_16x16x32_bf16 v[44:47], v[76:79], v[96:99], v[44:47]
    s_waitcnt lgkmcnt(8)
    v_mfma_f32_16x16x32_bf16 v[32:35], v[128:131], v[160:163], v[32:35]
    buffer_load_dwordx4 v214, s[24:27], s67 offen offset:2048 sc1 lds
    ds_read_b64 v[64:65], v199 offset:1600
    v_mfma_f32_16x16x32_bf16 v[32:35], v[132:135], v[164:167], v[32:35]
    ds_read_b64 v[66:67], v199 offset:1608
    s_waitcnt lgkmcnt(8)
    v_mfma_f32_16x16x32_bf16 v[32:35], v[136:139], v[168:171], v[32:35]
    ds_read_b128 v[96:99], v195 offset:8192
    s_waitcnt lgkmcnt(6)
    v_mfma_f32_16x16x32_bf16 v[32:35], v[140:143], v[172:175], v[32:35]
    ds_read_b64 v[68:69], v199 offset:1088
    s_waitcnt lgkmcnt(6)
    v_mfma_f32_16x16x32_bf16 v[36:39], v[128:131], v[176:179], v[36:39]
    ds_read_b64 v[70:71], v199 offset:1096
    v_mfma_f32_16x16x32_bf16 v[36:39], v[132:135], v[160:163], v[36:39]
    buffer_load_dwordx4 v215, s[24:27], s67 offen offset:3072 sc1 lds
    s_add_u32 m0, m0, 4096
    s_add_u32 s67, s67, 294912
    ds_read_b128 v[100:103], v195 offset:6144
    v_mfma_f32_16x16x32_bf16 v[36:39], v[136:139], v[164:167], v[36:39]
    ds_read_b64 v[72:73], v199 offset:576
    v_mfma_f32_16x16x32_bf16 v[36:39], v[140:143], v[168:171], v[36:39]
    ds_read_b64 v[74:75], v199 offset:584
    s_waitcnt lgkmcnt(8)
    v_mfma_f32_16x16x32_bf16 v[40:43], v[128:131], v[180:183], v[40:43]
    ds_read_b128 v[104:107], v195 offset:4096
    v_mfma_f32_16x16x32_bf16 v[40:43], v[132:135], v[176:179], v[40:43]
    ds_read_b64 v[76:77], v199 offset:64
    v_mfma_f32_16x16x32_bf16 v[40:43], v[136:139], v[160:163], v[40:43]
    buffer_load_dwordx4 v212, s[24:27], s67 offen offset:0 sc1 lds
    ds_read_b64 v[78:79], v199 offset:72
    v_mfma_f32_16x16x32_bf16 v[40:43], v[140:143], v[164:167], v[40:43]
    ds_read_b128 v[108:111], v195 offset:2048
    v_mfma_f32_16x16x32_bf16 v[44:47], v[128:131], v[184:187], v[44:47]
    ds_read_b128 v[112:115], v195 offset:10240
    v_mfma_f32_16x16x32_bf16 v[44:47], v[132:135], v[180:183], v[44:47]
    ds_read_b128 v[116:119], v195 offset:12288
    v_mfma_f32_16x16x32_bf16 v[44:47], v[136:139], v[176:179], v[44:47]
    buffer_load_dwordx4 v213, s[24:27], s67 offen offset:1024 sc1 lds
    ds_read_b128 v[120:123], v195 offset:14336
    v_mfma_f32_16x16x32_bf16 v[44:47], v[140:143], v[160:163], v[44:47]
    s_waitcnt lgkmcnt(8)
    v_mfma_f32_16x16x32_bf16 v[32:35], v[64:67], v[96:99], v[32:35]
    v_mfma_f32_16x16x32_bf16 v[32:35], v[68:71], v[100:103], v[32:35]
    s_waitcnt lgkmcnt(6)
    v_mfma_f32_16x16x32_bf16 v[32:35], v[72:75], v[104:107], v[32:35]
    s_branch PG_4_go
PG_4_prev_end:
    .p2align 12
PG_4:
    s_setpc_b64 s[82:83]
PG_4_go:
    s_waitcnt lgkmcnt(3)
    v_mfma_f32_16x16x32_bf16 v[32:35], v[76:79], v[108:111], v[32:35]
    buffer_load_dwordx4 v214, s[24:27], s67 offen offset:2048 sc1 lds
    s_waitcnt lgkmcnt(2)
    v_mfma_f32_16x16x32_bf16 v[36:39], v[64:67], v[112:115], v[36:39]
    v_mfma_f32_16x16x32_bf16 v[36:39], v[68:71], v[96:99], v[36:39]
    v_mfma_f32_16x16x32_bf16 v[36:39], v[72:75], v[100:103], v[36:39]
    v_mfma_f32_16x16x32_bf16 v[36:39], v[76:79], v[104:107], v[36:39]
    s_waitcnt lgkmcnt(1)
    v_mfma_f32_16x16x32_bf16 v[40:43], v[64:67], v[116:119], v[40:43]
    buffer_load_dwordx4 v215, s[24:27], s67 offen offset:3072 sc1 lds
    s_add_u32 s67, s67, 294912
    v_mfma_f32_16x16x32_bf16 v[40:43], v[68:71], v[112:115], v[40:43]
    v_mfma_f32_16x16x32_bf16 v[40:43], v[72:75], v[96:99], v[40:43]
    v_mfma_f32_16x16x32_bf16 v[40:43], v[76:79], v[100:103], v[40:43]
    v_cvt_pk_bf16_f32 v56, v32, v33
    v_cvt_pk_bf16_f32 v57, v34, v35
    ds_write_b64 v205, v[56:57] offset:0
    s_waitcnt lgkmcnt(1)
    v_mfma_f32_16x16x32_bf16 v[44:47], v[64:67], v[120:123], v[44:47]
    v_mfma_f32_16x16x32_bf16 v[44:47], v[68:71], v[116:119], v[44:47]
    v_mfma_f32_16x16x32_bf16 v[44:47], v[72:75], v[112:115], v[44:47]
    v_cvt_pk_bf16_f32 v58, v36, v37
    v_cvt_pk_bf16_f32 v59, v38, v39
    ds_write_b64 v205, v[58:59] offset:576
    v_mfma_f32_16x16x32_bf16 v[44:47], v[76:79], v[96:99], v[44:47]
    s_nop 1
    v_cvt_pk_bf16_f32 v60, v40, v41
    v_cvt_pk_bf16_f32 v61, v42, v43
    ds_write_b64 v205, v[60:61] offset:1152
    s_nop 2
    v_cvt_pk_bf16_f32 v62, v44, v45
    v_cvt_pk_bf16_f32 v63, v46, v47
    ds_write_b64 v205, v[62:63] offset:1728
    s_waitcnt lgkmcnt(0)
    s_barrier
    ds_read_b64_tr_b16 v[4:5], v207 offset:0
    ds_read_b64_tr_b16 v[6:7], v207 offset:32
    ds_read_b64_tr_b16 v[8:9], v207 offset:64
    ds_read_b64_tr_b16 v[10:11], v207 offset:96
    s_waitcnt lgkmcnt(3)
    buffer_store_dwordx2 v[4:5], v13, s[20:23], s18 offen offset:0 sc1
    s_waitcnt lgkmcnt(2)
    buffer_store_dwordx2 v[6:7], v13, s[20:23], s18 offen offset:512 sc1
    s_waitcnt lgkmcnt(1)
    buffer_store_dwordx2 v[8:9], v13, s[20:23], s18 offen offset:1024 sc1
    s_waitcnt lgkmcnt(0)
    buffer_store_dwordx2 v[10:11], v13, s[20:23], s18 offen offset:1536 sc1
KP_wload:

    s_nop 0
    s_waitcnt vmcnt(16) lgkmcnt(0)
    s_barrier
    ds_read_b64_tr_b16 v[224:225], v208 offset:0
    ds_read_b64_tr_b16 v[226:227], v208 offset:2048
    ds_read_b64_tr_b16 v[228:229], v209 offset:0
    ds_read_b64_tr_b16 v[230:231], v209 offset:2048
    ds_read_b64_tr_b16 v[232:233], v208 offset:16384
    ds_read_b64_tr_b16 v[234:235], v208 offset:18432
    ds_read_b64_tr_b16 v[236:237], v209 offset:16384
    ds_read_b64_tr_b16 v[238:239], v209 offset:18432
    ds_read_b64_tr_b16 v[240:241], v208 offset:4096
    ds_read_b64_tr_b16 v[242:243], v208 offset:6144
    ds_read_b64_tr_b16 v[244:245], v209 offset:4096
    ds_read_b64_tr_b16 v[246:247], v209 offset:6144
    ds_read_b64_tr_b16 v[248:249], v208 offset:20480
    ds_read_b64_tr_b16 v[250:251], v208 offset:22528
    ds_read_b64_tr_b16 v[252:253], v209 offset:20480
    ds_read_b64_tr_b16 v[254:255], v209 offset:22528
    s_waitcnt vmcnt(8) lgkmcnt(0)
    s_barrier
    s_add_u32 m0, s31, 0
    s_nop 0
    buffer_load_dwordx4 v212, s[24:27], s67 offen offset:0 sc1 lds
    ds_read_b64_tr_b16 a[0:1], v208 offset:32768
    ds_read_b64_tr_b16 a[2:3], v208 offset:34816
    s_load_dwordx2 s[28:29], s[0:1], 104
    s_load_dwordx2 s[76:77], s[0:1], 0
    v_lshlrev_b32 v5, 4, v1
    s_min_u32 s15, s64, 2
    s_mul_i32 s16, s64, 18
    s_add_u32 s16, s16, s15
    s_cmp_lt_u32 s64, 2
    s_cselect_b32 s17, 19, 18
    s_bfe_u32 s8, s2, 0x20001
    buffer_load_dwordx4 v213, s[24:27], s67 offen offset:1024 sc1 lds
    ds_read_b64_tr_b16 a[4:5], v209 offset:32768
    ds_read_b64_tr_b16 a[6:7], v209 offset:34816
    s_lshl_b32 s30, s17, 1
    s_sub_u32 s30, s30, 1
    v_min_u32 v196, s30, v1
    v_min_u32 v16, 7, v1
    v_min_u32 v17, 11, v1
    v_sub_u32 v18, s30, v16
    v_sub_u32 v19, s30, v17
    s_lshl_b32 s7, s16, 8
    s_add_u32 s7, s7, 47845376
    buffer_load_dwordx4 v214, s[24:27], s67 offen offset:2048 sc1 lds
    ds_read_b64_tr_b16 a[8:9], v208 offset:49152
    ds_read_b64_tr_b16 a[10:11], v208 offset:51200
    v_lshl_add_u32 v196, v196, 7, s7
    s_mul_i32 s15, s63, 7282
    s_lshr_b32 s15, s15, 16
    s_add_u32 s15, s15, s63
    s_add_u32 s15, s15, s64
    s_add_u32 s30, s16, s17
    s_sub_u32 s30, s30, 1
    s_bitcmp1_b32 s15, 0
    s_cselect_b32 s16, s30, s16
    s_cselect_b32 s38, -1, 1
    s_cselect_b64 vcc, -1, 0
    buffer_load_dwordx4 v215, s[24:27], s67 offen offset:3072 sc1 lds
    s_add_u32 m0, m0, 4096
    s_add_u32 s67, s67, 294912
    ds_read_b64_tr_b16 a[12:13], v209 offset:49152
    ds_read_b64_tr_b16 a[14:15], v209 offset:51200
    v_cndmask_b32 v16, v16, v18, vcc
    v_cndmask_b32 v17, v17, v19, vcc
    v_lshl_add_u32 v16, v16, 7, s7
    v_lshl_add_u32 v17, v17, 7, s7
    s_mul_i32 s39, s38, 18432
    s_lshl_b32 s38, s38, 10
    s_mul_i32 s34, s6, 4608
    buffer_load_dwordx4 v212, s[24:27], s67 offen offset:0 sc1 lds
    ds_read_b64_tr_b16 a[16:17], v208 offset:36864
    ds_read_b64_tr_b16 a[18:19], v208 offset:38912
    s_mul_i32 s32, s16, 18432
    s_add_u32 s32, s32, s34
    s_add_u32 s32, s32, 11796480
    s_add_u32 s34, s34, 108544
    v_add_u32 v10, 108544, v5
    s_lshl_b32 s35, s63, 2
    s_add_u32 s35, s35, s6
    s_lshl_b32 s35, s35, 7
    s_add_u32 s35, s35, s16
    buffer_load_dwordx4 v213, s[24:27], s67 offen offset:1024 sc1 lds
    ds_read_b64_tr_b16 a[20:21], v209 offset:36864
    ds_read_b64_tr_b16 a[22:23], v209 offset:38912
    s_lshl_b32 s35, s35, 10
    s_add_u32 s35, s35, 14155776
    s_sub_u32 s35, s35, s38
    s_mov_b32 s44, s4
    s_mov_b32 s45, s5
    s_mov_b32 s46, 0x10000000
    s_mov_b32 s47, 0x00020000
    s_mov_b32 s40, s4
    s_mov_b32 s41, s5
    buffer_load_dwordx4 v214, s[24:27], s67 offen offset:2048 sc1 lds
    ds_read_b64_tr_b16 a[24:25], v208 offset:53248
    ds_read_b64_tr_b16 a[26:27], v208 offset:55296
    s_mov_b32 s42, 0
    s_mov_b32 s43, 0x00020000
    s_mov_b32 s48, s4
    s_mov_b32 s49, s5
    s_mov_b32 s50, 0
    s_mov_b32 s51, 0x00020000
    s_mov_b32 s52, s4
    s_mov_b32 s53, s5
    s_mov_b32 s54, 0
    buffer_load_dwordx4 v215, s[24:27], s67 offen offset:3072 sc1 lds
    s_add_u32 s67, s67, 294912
    ds_read_b64_tr_b16 a[28:29], v209 offset:53248
    ds_read_b64_tr_b16 a[30:31], v209 offset:55296
    s_mov_b32 s55, 0x00020000
    s_lshl_b32 s7, s62, 7
    s_add_u32 s7, s7, 47775744
    v_mov_b32 v11, s7
    v_cmp_eq_u32 vcc, 0, v0
    v_mov_b32 v12, -1
    s_nop 0
    v_cndmask_b32 v11, 2.0, v11, vcc
    s_bitcmp1_b32 s3, 0
    s_cselect_b32 s50, 0x10000000, 0
    s_cmp_eq_u32 s3, 3
    s_cbranch_scc1 KP_ln2
KP_wret:

    s_waitcnt vmcnt(8) lgkmcnt(0)
    s_barrier
    s_add_u32 m0, s31, 32768
    s_nop 0
    buffer_load_dwordx4 v212, s[24:27], s67 offen offset:0 sc1 lds
    ds_read_b64_tr_b16 a[32:33], v210 offset:0
    ds_read_b64_tr_b16 a[34:35], v210 offset:2048
    s_and_b32 s9, s2, 1
    s_lshl_b32 s9, s9, 3
    s_lshr_b32 s10, s2, 5
    s_add_u32 s9, s9, s10
    s_bfe_u32 s10, s2, 0x20003
    buffer_load_dwordx4 v213, s[24:27], s67 offen offset:1024 sc1 lds
    ds_read_b64_tr_b16 a[36:37], v211 offset:0
    ds_read_b64_tr_b16 a[38:39], v211 offset:2048
    s_lshr_b32 s11, 40142, s9
    s_and_b32 s11, s11, 1
    s_mov_b32 s54, 0x10000000
    s_lshl_b32 s30, s9, 3
    s_lshl_b32 s33, s6, 1
    s_add_u32 s33, s33, s30
    buffer_load_dwordx4 v214, s[24:27], s67 offen offset:2048 sc1 lds
    ds_read_b64_tr_b16 a[40:41], v210 offset:16384
    ds_read_b64_tr_b16 a[42:43], v210 offset:18432
    v_and_b32 v2, 1, v1
    v_add_u32 v2, s33, v2
    v_add_u32 v3, -2, v2
    v_mul_u32_u24 v3, 3641, v3
    v_lshrrev_b32 v3, 16, v3
    buffer_load_dwordx4 v215, s[24:27], s67 offen offset:3072 sc1 lds
    s_add_u32 m0, m0, 4096
    s_add_u32 s67, s67, 294912
    ds_read_b64_tr_b16 a[44:45], v211 offset:16384
    ds_read_b64_tr_b16 a[46:47], v211 offset:18432
    v_cmp_lt_u32 vcc, 18, v2
    v_lshrrev_b32 v24, 1, v1
    v_min_u32 v24, 8, v24
    v_cndmask_b32 v25, 0, 1, vcc
    v_cmp_lt_u32 vcc, 37, v2
    s_mul_i32 s30, s8, 9
    buffer_load_dwordx4 v212, s[24:27], s67 offen offset:0 sc1 lds
    ds_read_b64_tr_b16 a[48:49], v210 offset:4096
    ds_read_b64_tr_b16 a[50:51], v210 offset:6144
    v_add_u32 v26, s30, v24
    v_cndmask_b32 v3, v25, v3, vcc
    v_mul_u32_u24 v26, 7, v26
    v_add_u32 v26, v26, v3
    v_lshlrev_b32 v13, 7, v26
    buffer_load_dwordx4 v213, s[24:27], s67 offen offset:1024 sc1 lds
    ds_read_b64_tr_b16 a[52:53], v211 offset:4096
    ds_read_b64_tr_b16 a[54:55], v211 offset:6144
    v_add_u32 v13, 47775744, v13
    v_cndmask_b32 v25, 19, 18, vcc
    v_min_u32 v26, 2, v3
    v_mad_u32_u24 v26, v3, 18, v26
    v_sub_u32 v26, v2, v26
    v_sub_u32 v25, v25, v26
    buffer_load_dwordx4 v214, s[24:27], s67 offen offset:2048 sc1 lds
    ds_read_b64_tr_b16 a[56:57], v210 offset:20480
    ds_read_b64_tr_b16 a[58:59], v210 offset:22528
    v_add_u32 v26, 1, v26
    v_add_u32 v3, v3, v24
    v_and_b32 v3, 1, v3
    v_cmp_eq_u32 vcc, 1, v3
    v_and_b32 v24, 1, v24
    buffer_load_dwordx4 v215, s[24:27], s67 offen offset:3072 sc1 lds
    s_add_u32 s67, s67, 294912
    ds_read_b64_tr_b16 a[60:61], v211 offset:20480
    ds_read_b64_tr_b16 a[62:63], v211 offset:22528
    s_lshl_b32 s72, s8, 2
    v_cndmask_b32 v14, v26, v25, vcc
    v_cmp_eq_u32 vcc, s11, v24
    s_add_u32 s72, s72, s10
    s_mul_i32 s72, s72, 331776
    v_cndmask_b32 v15, 0, v14, vcc
    s_cmp_eq_u32 s3, 3
    s_cbranch_scc0 KP_lz0
    s_waitcnt vmcnt(8)
KP_lz0:
    s_waitcnt vmcnt(8) lgkmcnt(0)
    s_barrier
    s_cbranch_scc0 KP_lz1
    buffer_store_dword v60, v148, s[20:23], 0 offen sc1
KP_lz1:
    s_add_u32 m0, s31, 65536
    s_nop 0
    buffer_load_dwordx4 v212, s[24:27], s67 offen offset:0 sc1 lds
    ds_read_b64_tr_b16 a[64:65], v208 offset:0
    ds_read_b64_tr_b16 a[66:67], v208 offset:2048
    s_add_u32 s72, s72, 42467328
    s_mul_i32 s73, s11, 184320
    s_mul_i32 s57, s6, 18432
    s_add_u32 s56, s72, s73
    s_add_u32 s56, s56, s57
    buffer_load_dwordx4 v213, s[24:27], s67 offen offset:1024 sc1 lds
    ds_read_b64_tr_b16 a[68:69], v209 offset:0
    ds_read_b64_tr_b16 a[70:71], v209 offset:2048
    s_add_u32 s73, s73, 73728
    s_mul_i32 s59, s6, 9216
    s_add_u32 s72, s72, s59
    s_add_u32 s60, s72, s73
    s_add_u32 s73, s72, 331776
    s_add_u32 s75, s8, 1
    buffer_load_dwordx4 v214, s[24:27], s67 offen offset:2048 sc1 lds
    ds_read_b64_tr_b16 a[72:73], v208 offset:16384
    ds_read_b64_tr_b16 a[74:75], v208 offset:18432
    s_mul_i32 s75, s75, 4718592
    s_add_u32 s75, s75, 14155776
    s_mul_i32 s74, s8, 9
    s_add_u32 s74, s74, s11
    s_lshl_b32 s74, s74, 9
    buffer_load_dwordx4 v215, s[24:27], s67 offen offset:3072 sc1 lds
    s_add_u32 m0, m0, 4096
    s_add_u32 s67, s67, 294912
    ds_read_b64_tr_b16 a[76:77], v209 offset:16384
    ds_read_b64_tr_b16 a[78:79], v209 offset:18432
    s_add_u32 s74, s74, s33
    s_lshl_b32 s74, s74, 10
    s_add_u32 s74, s74, 14155776
    v_add_u32 v3, 36864, v5
    v_add_u32 v4, 73728, v5
    s_nop 0
    buffer_load_dwordx4 v212, s[24:27], s67 offen offset:0 sc1 lds
    ds_read_b64_tr_b16 a[80:81], v208 offset:4096
    ds_read_b64_tr_b16 a[82:83], v208 offset:6144
    s_lshl_b32 s7, s65, 7
    s_add_u32 s7, s7, 47827008
    v_mov_b32 v197, s7
    v_cmp_eq_u32 vcc, 0, v0
    v_mov_b32 v19, -1
    buffer_load_dwordx4 v213, s[24:27], s67 offen offset:1024 sc1 lds
    ds_read_b64_tr_b16 a[84:85], v209 offset:4096
    ds_read_b64_tr_b16 a[86:87], v209 offset:6144
    s_nop 0
    v_cndmask_b32 v197, 2.0, v197, vcc
    s_sub_u32 s14, s17, 3
    s_lshl_b32 s37, 5, s17
    s_lshr_b32 s37, s37, 5
    s_or_b32 s37, s37, 1026
    buffer_load_dwordx4 v214, s[24:27], s67 offen offset:2048 sc1 lds
    ds_read_b64_tr_b16 a[88:89], v208 offset:20480
    ds_read_b64_tr_b16 a[90:91], v208 offset:22528
    s_add_u32 s33, s17, 1339
    s_cmp_eq_u32 s3, 1
    s_cselect_b32 s7, 0, 2.0
    s_cselect_b32 s79, s14, 0
    v_or_b32 v197, s7, v197
    buffer_load_dwordx4 v215, s[24:27], s67 offen offset:3072 sc1 lds
    s_add_u32 s67, s67, 294912
    ds_read_b64_tr_b16 a[92:93], v209 offset:20480
    ds_read_b64_tr_b16 a[94:95], v209 offset:22528
    v_mov_b32 v191, 2.0
    v_mov_b32 v190, v13
    v_min_u32 v192, 35, v1
    s_mul_i32 s30, s8, 4608
    s_add_u32 s30, s30, 47827008
    v_lshl_add_u32 v192, v192, 7, s30
    s_waitcnt vmcnt(8) lgkmcnt(0)
    s_barrier
    s_add_u32 m0, s31, 0
    s_nop 0
    buffer_load_dwordx4 v212, s[24:27], s67 offen offset:0 sc1 lds
    ds_read_b64_tr_b16 a[96:97], v208 offset:32768
    ds_read_b64_tr_b16 a[98:99], v208 offset:34816
    v_mov_b32 v13, v17
    v_mov_b32 v193, 1
    s_nop 0
    s_cmp_eq_u32 s3, 2
    s_cselect_b32 s7, 1, 63
    buffer_load_dwordx4 v213, s[24:27], s67 offen offset:1024 sc1 lds
    ds_read_b64_tr_b16 a[100:101], v209 offset:32768
    ds_read_b64_tr_b16 a[102:103], v209 offset:34816
    v_min_u32 v2, 2, v1
    v_sub_u32 v2, 3, v2
    v_xor_b32 v2, s8, v2
    v_subrev_u32 v2, s8, v2
    v_mul_i32_i24 v2, s7, v2
    v_add_u32 v2, s62, v2
    buffer_load_dwordx4 v214, s[24:27], s67 offen offset:2048 sc1 lds
    ds_read_b64_tr_b16 a[104:105], v208 offset:49152
    ds_read_b64_tr_b16 a[106:107], v208 offset:51200
    v_lshlrev_b32 v2, 7, v2
    v_add_u32 v216, 47775744, v2
    s_lshl_b32 s12, s9, 2
    s_add_u32 s12, s12, s10
    s_lshl_b32 s12, s12, 2
    buffer_load_dwordx4 v215, s[24:27], s67 offen offset:3072 sc1 lds
    s_add_u32 m0, m0, 4096
    s_add_u32 s67, s67, 294912
    ds_read_b64_tr_b16 a[108:109], v209 offset:49152
    ds_read_b64_tr_b16 a[110:111], v209 offset:51200
    s_add_u32 s13, s12, s6
    s_lshl_b32 s13, s13, 2
    s_add_u32 s13, s13, s8
    s_mul_i32 s62, s13, 9216
    s_add_u32 s62, s62, 33030144
    s_add_u32 s12, s12, s8
    buffer_load_dwordx4 v212, s[24:27], s67 offen offset:0 sc1 lds
    ds_read_b64_tr_b16 a[112:113], v208 offset:36864
    ds_read_b64_tr_b16 a[114:115], v208 offset:38912
    s_mul_i32 s15, s12, 36864
    s_add_u32 s15, s15, 33030144
    s_cmp_eq_u32 s6, s8
    s_cselect_b32 s7, 2.0, 0
    v_add_u32 v219, s7, v5
    v_mov_b64 v[220:221], -1
    v_mov_b64 v[222:223], -1
    v_and_b32 v2, 15, v1
    v_lshrrev_b32 v24, 4, v1
    v_mul_u32_u24 v25, 16512, v24
    v_lshl_add_u32 v7, v2, 3, v25
    v_add_u32 v6, v25, v7
    v_mul_u32_u24 v25, 1152, v2
    v_lshl_add_u32 v8, v24, 4, v25
    v_lshl_add_u32 v9, v24, 3, v25
    s_cselect_b32 s7, 0, 2.0
    buffer_load_dwordx4 v213, s[24:27], s67 offen offset:1024 sc1 lds
    ds_read_b64_tr_b16 a[116:117], v209 offset:36864
    ds_read_b64_tr_b16 a[118:119], v209 offset:38912
    buffer_load_dwordx4 v214, s[24:27], s67 offen offset:2048 sc1 lds
    ds_read_b64_tr_b16 a[120:121], v208 offset:53248
    ds_read_b64_tr_b16 a[122:123], v208 offset:55296
    v_add_u32 v7, s7, v7
    buffer_load_dwordx4 v215, s[24:27], s67 offen offset:3072 sc1 lds
    s_add_u32 s67, s67, 294912
    ds_read_b64_tr_b16 a[124:125], v209 offset:53248
    ds_read_b64_tr_b16 a[126:127], v209 offset:55296
    v_add_u32 v9, s7, v9
    v_add_u32 v217, s7, v5
    s_lshl_b32 s16, s9, 3
    s_lshl_b32 s7, s6, 1
    s_add_u32 s16, s16, s7
    s_waitcnt vmcnt(8) lgkmcnt(0)
    s_barrier
    s_add_u32 m0, s31, 32768
    s_nop 0
    buffer_load_dwordx4 v212, s[24:27], s67 offen offset:0 sc1 lds
    ds_read_b64_tr_b16 a[128:129], v210 offset:0
    ds_read_b64_tr_b16 a[130:131], v210 offset:2048
    s_sub_u32 s7, s16, 2
    s_mul_i32 s7, s7, 3641
    s_lshr_b32 s7, s7, 16
    s_cmp_ge_u32 s16, 19
    s_cselect_b32 s12, 1, 0
    s_cmp_ge_u32 s16, 38
    s_cselect_b32 s7, s7, s12
    s_cselect_b32 s12, 35, 37
    buffer_load_dwordx4 v213, s[24:27], s67 offen offset:1024 sc1 lds
    ds_read_b64_tr_b16 a[132:133], v211 offset:0
    ds_read_b64_tr_b16 a[134:135], v211 offset:2048
    s_min_u32 s13, s7, 2
    s_mul_i32 s18, s7, 18
    s_add_u32 s13, s13, s18
    buffer_load_dwordx4 v214, s[24:27], s67 offen offset:2048 sc1 lds
    ds_read_b64_tr_b16 a[136:137], v210 offset:16384
    ds_read_b64_tr_b16 a[138:139], v210 offset:18432
    s_sub_u32 s13, s16, s13
    s_lshl_b32 s13, s13, 1
    s_sub_u32 s12, s12, s13
    s_min_u32 s13, s13, s12
    s_mul_i32 s13, s13, 7
    s_add_u32 s18, s13, s7
    buffer_load_dwordx4 v215, s[24:27], s67 offen offset:3072 sc1 lds
    s_add_u32 m0, m0, 4096
    s_add_u32 s67, s67, 294912
    ds_read_b64_tr_b16 a[140:141], v211 offset:16384
    ds_read_b64_tr_b16 a[142:143], v211 offset:18432
    s_add_u32 s16, s16, 1
    s_sub_u32 s7, s16, 2
    s_mul_i32 s7, s7, 3641
    s_lshr_b32 s7, s7, 16
    s_cmp_ge_u32 s16, 19
    s_cselect_b32 s12, 1, 0
    buffer_load_dwordx4 v212, s[24:27], s67 offen offset:0 sc1 lds
    ds_read_b64_tr_b16 a[144:145], v210 offset:4096
    ds_read_b64_tr_b16 a[146:147], v210 offset:6144
    s_cmp_ge_u32 s16, 38
    s_cselect_b32 s7, s7, s12
    s_cselect_b32 s12, 35, 37
    s_min_u32 s13, s7, 2
    s_mul_i32 s19, s7, 18
    buffer_load_dwordx4 v213, s[24:27], s67 offen offset:1024 sc1 lds
    ds_read_b64_tr_b16 a[148:149], v211 offset:4096
    ds_read_b64_tr_b16 a[150:151], v211 offset:6144
    s_add_u32 s13, s13, s19
    s_sub_u32 s13, s16, s13
    s_lshl_b32 s13, s13, 1
    s_sub_u32 s12, s12, s13
    s_min_u32 s13, s13, s12
    buffer_load_dwordx4 v214, s[24:27], s67 offen offset:2048 sc1 lds
    ds_read_b64_tr_b16 a[152:153], v210 offset:20480
    ds_read_b64_tr_b16 a[154:155], v210 offset:22528
    s_mul_i32 s13, s13, 7
    s_add_u32 s19, s13, s7
    s_add_u32 s16, s16, 1
    s_sub_u32 s19, s19, s18
    s_lshl_b32 s7, s10, 2
    s_add_u32 s7, s7, s8
    buffer_load_dwordx4 v215, s[24:27], s67 offen offset:3072 sc1 lds
    s_add_u32 s67, s67, 294912
    ds_read_b64_tr_b16 a[156:157], v211 offset:20480
    ds_read_b64_tr_b16 a[158:159], v211 offset:22528
    s_mul_i32 s12, s7, 132096
    s_lshl_b32 s16, s18, 7
    s_add_u32 s16, s16, 4718592
    s_add_u32 s12, s12, s16
    s_add_u32 s13, s10, 32
    s_branch PG_5_go
PG_5_prev_end:
    .p2align 12
PG_5:
    s_setpc_b64 s[82:83]
PG_5_go:
    s_waitcnt vmcnt(8) lgkmcnt(0)
    s_barrier
    buffer_load_dword v18, v16, s[48:51], 0 offen sc1
    s_add_u32 m0, s31, 65536
    s_nop 0
    buffer_load_dwordx4 v212, s[24:27], s67 offen offset:0 sc1 lds
    ds_read_b64_tr_b16 a[160:161], v208 offset:0
    ds_read_b64_tr_b16 a[162:163], v208 offset:2048
    s_mul_i32 s13, s13, 66048
    s_add_u32 s13, s13, s16
    s_mul_i32 s16, s18, 18432
    s_lshl_b32 s18, s10, 5
    s_add_u32 s18, s18, s16
    s_add_u32 s18, s18, 1024
    buffer_load_dwordx4 v213, s[24:27], s67 offen offset:1024 sc1 lds
    ds_read_b64_tr_b16 a[164:165], v209 offset:0
    ds_read_b64_tr_b16 a[166:167], v209 offset:2048
    s_lshl_b32 s7, s7, 6
    s_add_u32 s16, s16, s7
    s_mul_i32 s61, s8, 9
    s_sub_u32 s7, s63, s61
    s_and_b32 s30, s7, 1
    buffer_load_dwordx4 v214, s[24:27], s67 offen offset:2048 sc1 lds
    ds_read_b64_tr_b16 a[168:169], v208 offset:16384
    ds_read_b64_tr_b16 a[170:171], v208 offset:18432
    s_mul_i32 s30, s30, 5
    s_lshr_b32 s7, s7, 1
    s_add_u32 s7, s7, s30
    s_lshl_b32 s63, s8, 2
    s_add_u32 s63, s63, s6
    s_mul_i32 s63, s63, 9
    buffer_load_dwordx4 v215, s[24:27], s67 offen offset:3072 sc1 lds
    s_add_u32 m0, m0, 4096
    s_add_u32 s67, s67, 294912
    ds_read_b64_tr_b16 a[172:173], v209 offset:16384
    ds_read_b64_tr_b16 a[174:175], v209 offset:18432
    s_add_u32 s63, s63, s7
    s_mul_i32 s63, s63, 36
    s_and_b32 s7, s65, 3
    s_add_u32 s63, s63, s7
    s_lshl_b32 s63, s63, 10
    buffer_load_dwordx4 v212, s[24:27], s67 offen offset:0 sc1 lds
    ds_read_b64_tr_b16 a[176:177], v208 offset:4096
    ds_read_b64_tr_b16 a[178:179], v208 offset:6144
    s_add_u32 s63, s63, 42467328
    v_lshrrev_b32 v2, 2, v1
    v_mul_u32_u24 v2, 1152, v2
    v_and_b32 v20, 3, v1
    s_lshl_b32 s7, s6, 8
    v_lshl_add_u32 v188, v20, 4, v2
    buffer_load_dwordx4 v213, s[24:27], s67 offen offset:1024 sc1 lds
    ds_read_b64_tr_b16 a[180:181], v209 offset:4096
    ds_read_b64_tr_b16 a[182:183], v209 offset:6144
    v_add_u32 v188, s7, v188
    s_lshl_b32 s7, s6, 5
    s_add_u32 s7, s7, 1024
    v_lshl_add_u32 v189, v20, 3, v2
    v_add_u32 v189, s7, v189
    buffer_load_dwordx4 v214, s[24:27], s67 offen offset:2048 sc1 lds
    ds_read_b64_tr_b16 a[184:185], v208 offset:20480
    ds_read_b64_tr_b16 a[186:187], v208 offset:22528
    s_xor_b32 s7, s8, 3
    s_lshl_b32 s7, s7, 6
    v_add_u32 v198, s7, v188
    s_xor_b32 s7, s8, 2
    s_lshl_b32 s7, s7, 6
    v_add_u32 v199, s7, v188
    buffer_load_dwordx4 v215, s[24:27], s67 offen offset:3072 sc1 lds
    s_add_u32 s67, s67, 294912
    ds_read_b64_tr_b16 a[188:189], v209 offset:20480
    ds_read_b64_tr_b16 a[190:191], v209 offset:22528
    s_xor_b32 s7, s8, 1
    s_lshl_b32 s7, s7, 6
    v_add_u32 v200, s7, v188
    s_xor_b32 s7, s8, 0
    s_lshl_b32 s7, s7, 6
    v_add_u32 v201, s7, v188
    s_waitcnt vmcnt(8) lgkmcnt(0)
    s_barrier
    ds_read_b64_tr_b16 a[192:193], v208 offset:32768
    ds_read_b64_tr_b16 a[194:195], v208 offset:34816
    ds_read_b64_tr_b16 a[196:197], v209 offset:32768
    ds_read_b64_tr_b16 a[198:199], v209 offset:34816
    ds_read_b64_tr_b16 a[200:201], v208 offset:49152
    ds_read_b64_tr_b16 a[202:203], v208 offset:51200
    ds_read_b64_tr_b16 a[204:205], v209 offset:49152
    ds_read_b64_tr_b16 a[206:207], v209 offset:51200
    ds_read_b64_tr_b16 a[208:209], v208 offset:36864
    ds_read_b64_tr_b16 a[210:211], v208 offset:38912
    ds_read_b64_tr_b16 a[212:213], v209 offset:36864
    ds_read_b64_tr_b16 a[214:215], v209 offset:38912
    ds_read_b64_tr_b16 a[216:217], v208 offset:53248
    ds_read_b64_tr_b16 a[218:219], v208 offset:55296
    ds_read_b64_tr_b16 a[220:221], v209 offset:53248
    ds_read_b64_tr_b16 a[222:223], v209 offset:55296
    v_cmp_ne_u32 vcc, 1, v18
    s_cbranch_vccnz KP_wx
    s_call_b64 s[82:83], KP_xi
KP_wx:
    s_cmp_lg_u32 s66, 0
    s_cbranch_scc1 KP_w8
    s_waitcnt vmcnt(0)
KP_w8:
    s_waitcnt vmcnt(10) lgkmcnt(0)
    s_barrier
    ds_read_b64_tr_b16 a[224:225], v210 offset:0
    ds_read_b64_tr_b16 a[226:227], v210 offset:2048
    ds_read_b64_tr_b16 a[228:229], v211 offset:0
    ds_read_b64_tr_b16 a[230:231], v211 offset:2048
    ds_read_b64_tr_b16 a[232:233], v210 offset:16384
    ds_read_b64_tr_b16 a[234:235], v210 offset:18432
    ds_read_b64_tr_b16 a[236:237], v211 offset:16384
    ds_read_b64_tr_b16 a[238:239], v211 offset:18432
    ds_read_b64_tr_b16 a[240:241], v210 offset:4096
    ds_read_b64_tr_b16 a[242:243], v210 offset:6144
    ds_read_b64_tr_b16 a[244:245], v211 offset:4096
    ds_read_b64_tr_b16 a[246:247], v211 offset:6144
    ds_read_b64_tr_b16 a[248:249], v210 offset:20480
    ds_read_b64_tr_b16 a[250:251], v210 offset:22528
    ds_read_b64_tr_b16 a[252:253], v211 offset:20480
    ds_read_b64_tr_b16 a[254:255], v211 offset:22528
    s_bitcmp0_b32 s3, 0
    s_cbranch_scc1 KP_ln2
KP_xs:

    s_cmp_lg_u32 s66, 0
    s_cbranch_scc1 KP_xd
    s_mov_b32 s61, 1048576
    s_branch KP_x_f
KP_x:
    s_sleep 1
KP_x_f:
    buffer_load_dword v18, v16, s[20:23], 0 offen sc1
    s_sub_u32 s61, s61, 1
    s_cbranch_scc1 KP_x_x
    s_waitcnt vmcnt(0)
    v_cmp_ne_u32 vcc, 1, v18
    s_cbranch_vccnz KP_x
KP_x_x:
    s_call_b64 s[82:83], KP_xi
KP_xd:
    s_mov_b64 s[80:81], s[68:69]
    s_mul_i32 s31, s65, 36864
    s_add_u32 s31, s31, s59
    s_mov_b32 s24, s4
    s_mov_b32 s25, s5
    s_mov_b32 s26, 0x10000000
    s_mov_b32 s27, 0x00020000
    s_mov_b32 s64, s4
    s_mov_b32 s65, s5
    s_mov_b32 s66, 0
    s_mov_b32 s67, 0x00020000
    s_mov_b32 s68, s28
    s_mov_b32 s69, s29
    s_mov_b32 s70, 2359296
    s_mov_b32 s71, 0x00020000
    s_add_u32 m0, s34, 36864
    s_waitcnt vmcnt(5) lgkmcnt(0)
    s_barrier
    s_cmp_eq_u32 s3, 2
    s_cbranch_scc1 KP_idle
    ds_read_b128 v[48:51], v10 offset:0
    ds_read_b128 v[52:55], v10 offset:1024
    ds_read_b128 v[56:59], v10 offset:2048
    s_mov_b32 s36, 108544
    s_sub_u32 s34, s34, 108544
    s_sub_u32 s17, s17, 1
    s_cmp_eq_u32 s3, 1
    s_waitcnt lgkmcnt(0)
    s_cbranch_scc1 KP_bodyA
KP_loop1:

    v_mfma_f32_16x16x32_bf16 v[16:19], v[224:227], v[48:51], 0
    ds_read_b128 v[60:63], v10 offset:3072
    v_mfma_f32_16x16x32_bf16 v[16:19], v[240:243], v[52:55], v[16:19]
    ds_read_b128 v[64:67], v10 offset:4096
    v_mfma_f32_16x16x32_bf16 v[16:19], a[0:3], v[56:59], v[16:19]
    ds_read_b128 v[68:71], v10 offset:5120
    v_mfma_f32_16x16x32_bf16 v[20:23], v[228:231], v[48:51], 0
    buffer_load_dwordx4 v5, s[44:47], s32 offen offset:0 sc1 lds
    v_mfma_f32_16x16x32_bf16 v[20:23], v[244:247], v[52:55], v[20:23]
    s_sub_u32 s17, s17, 1
    v_mfma_f32_16x16x32_bf16 v[20:23], a[4:7], v[56:59], v[20:23]
    s_bitcmp1_b32 s37, s17
    v_mfma_f32_16x16x32_bf16 v[24:27], v[232:235], v[48:51], 0
    s_cselect_b32 s50, 0x10000000, 0
    v_mfma_f32_16x16x32_bf16 v[24:27], v[248:251], v[52:55], v[24:27]
    v_mul_f32 v32, v32, v40
    v_mfma_f32_16x16x32_bf16 v[24:27], a[8:11], v[56:59], v[24:27]
    v_mul_f32 v33, v33, v41
    v_mfma_f32_16x16x32_bf16 v[28:31], v[236:239], v[48:51], 0
    buffer_load_dwordx4 v5, s[44:47], s32 offen offset:1024 sc1 lds
    v_mfma_f32_16x16x32_bf16 v[28:31], v[252:255], v[52:55], v[28:31]
    v_mul_f32 v34, v34, v42
    v_mfma_f32_16x16x32_bf16 v[28:31], a[12:15], v[56:59], v[28:31]
    s_waitcnt lgkmcnt(0)
    v_mfma_f32_16x16x32_bf16 v[16:19], a[16:19], v[60:63], v[16:19]
    ds_read_b128 v[48:51], v10 offset:6144
    v_mfma_f32_16x16x32_bf16 v[16:19], a[32:35], v[64:67], v[16:19]
    ds_read_b128 v[52:55], v10 offset:7168
    v_mfma_f32_16x16x32_bf16 v[16:19], a[48:51], v[68:71], v[16:19]
    ds_read_b128 v[56:59], v10 offset:8192
    v_mfma_f32_16x16x32_bf16 v[20:23], a[20:23], v[60:63], v[20:23]
    buffer_load_dwordx4 v5, s[44:47], s32 offen offset:2048 sc1 lds
    v_mfma_f32_16x16x32_bf16 v[20:23], a[36:39], v[64:67], v[20:23]
    v_mul_f32 v35, v35, v43
    v_mfma_f32_16x16x32_bf16 v[20:23], a[52:55], v[68:71], v[20:23]
    v_cvt_pk_bf16_f32 v72, v32, v33
    v_mfma_f32_16x16x32_bf16 v[24:27], a[24:27], v[60:63], v[24:27]
    buffer_load_dword v76, v13, s[48:51], 0 offen sc1
    v_cvt_pk_bf16_f32 v73, v34, v35
    v_mfma_f32_16x16x32_bf16 v[24:27], a[40:43], v[64:67], v[24:27]
    v_mul_f32 v36, v36, v44
    v_mfma_f32_16x16x32_bf16 v[24:27], a[56:59], v[68:71], v[24:27]
    v_mul_f32 v37, v37, v45
    v_mfma_f32_16x16x32_bf16 v[28:31], a[28:31], v[60:63], v[28:31]
    buffer_load_dwordx4 v5, s[44:47], s32 offen offset:3072 sc1 lds
    v_mfma_f32_16x16x32_bf16 v[28:31], a[44:47], v[64:67], v[28:31]
    v_mul_f32 v38, v38, v46
    v_mfma_f32_16x16x32_bf16 v[28:31], a[60:63], v[68:71], v[28:31]
    s_waitcnt lgkmcnt(0)
    v_mfma_f32_16x16x32_bf16 v[16:19], a[64:67], v[48:51], v[16:19]
    ds_read_b128 v[60:63], v10 offset:9216
    v_mfma_f32_16x16x32_bf16 v[16:19], a[80:83], v[52:55], v[16:19]
    ds_read_b128 v[64:67], v10 offset:10240
    v_mfma_f32_16x16x32_bf16 v[16:19], a[96:99], v[56:59], v[16:19]
    ds_read_b128 v[68:71], v10 offset:11264
    v_mfma_f32_16x16x32_bf16 v[20:23], a[68:71], v[48:51], v[20:23]
    buffer_load_dwordx4 v5, s[44:47], s32 offen offset:3584 sc1 lds
    v_mfma_f32_16x16x32_bf16 v[20:23], a[84:87], v[52:55], v[20:23]
    v_mul_f32 v39, v39, v47
    v_mfma_f32_16x16x32_bf16 v[20:23], a[100:103], v[56:59], v[20:23]
    v_cvt_pk_bf16_f32 v74, v36, v37
    v_mfma_f32_16x16x32_bf16 v[24:27], a[72:75], v[48:51], v[24:27]
    v_cvt_pk_bf16_f32 v75, v38, v39
    v_mfma_f32_16x16x32_bf16 v[24:27], a[88:91], v[52:55], v[24:27]
    s_bitcmp1_b32 0x3fe, s17
    v_mfma_f32_16x16x32_bf16 v[24:27], a[104:107], v[56:59], v[24:27]
    s_cselect_b32 s66, 0x10000000, 0
    v_mfma_f32_16x16x32_bf16 v[28:31], a[76:79], v[48:51], v[28:31]
    buffer_store_dwordx4 v[72:75], v5, s[40:43], s35 offen sc1
    v_mfma_f32_16x16x32_bf16 v[28:31], a[92:95], v[52:55], v[28:31]
    s_cselect_b32 m0, s57, 0x30000
    v_mfma_f32_16x16x32_bf16 v[28:31], a[108:111], v[56:59], v[28:31]
    s_waitcnt lgkmcnt(0)
    v_mfma_f32_16x16x32_bf16 v[16:19], a[112:115], v[60:63], v[16:19]
    ds_read_b128 v[48:51], v10 offset:12288
    v_mfma_f32_16x16x32_bf16 v[16:19], a[128:131], v[64:67], v[16:19]
    ds_read_b128 v[52:55], v10 offset:13312
    v_mfma_f32_16x16x32_bf16 v[16:19], a[144:147], v[68:71], v[16:19]
    ds_read_b128 v[56:59], v10 offset:14336
    v_mfma_f32_16x16x32_bf16 v[20:23], a[116:119], v[60:63], v[20:23]
    buffer_load_dwordx4 v5, s[64:67], s56 offen offset:0 sc1 lds
    v_mfma_f32_16x16x32_bf16 v[20:23], a[132:135], v[64:67], v[20:23]
    s_cselect_b32 s58, 2048, 0
    v_mfma_f32_16x16x32_bf16 v[20:23], a[148:151], v[68:71], v[20:23]
    s_add_u32 s35, s35, s38
    v_mfma_f32_16x16x32_bf16 v[24:27], a[120:123], v[60:63], v[24:27]
    s_mov_b32 s42, 0x10000000
    v_mfma_f32_16x16x32_bf16 v[24:27], a[136:139], v[64:67], v[24:27]
    s_add_u32 s32, s32, s39
    v_mfma_f32_16x16x32_bf16 v[24:27], a[152:155], v[68:71], v[24:27]
    v_mfma_f32_16x16x32_bf16 v[28:31], a[124:127], v[60:63], v[28:31]
    buffer_load_dwordx4 v5, s[64:67], s56 offen offset:1024 sc1 lds
    v_mfma_f32_16x16x32_bf16 v[28:31], a[140:143], v[64:67], v[28:31]
    s_add_u32 s56, s56, s58
    v_mfma_f32_16x16x32_bf16 v[28:31], a[156:159], v[68:71], v[28:31]
    s_waitcnt lgkmcnt(0)
    v_mfma_f32_16x16x32_bf16 v[16:19], a[160:163], v[48:51], v[16:19]
    ds_read_b128 v[60:63], v10 offset:15360
    v_mfma_f32_16x16x32_bf16 v[16:19], a[176:179], v[52:55], v[16:19]
    ds_read_b128 v[64:67], v10 offset:16384
    v_mfma_f32_16x16x32_bf16 v[16:19], a[192:195], v[56:59], v[16:19]
    ds_read_b128 v[68:71], v10 offset:17408
    v_mfma_f32_16x16x32_bf16 v[20:23], a[164:167], v[48:51], v[20:23]
    buffer_store_dwordx4 v[220:223], v219, s[64:67], s62 offen sc1
    v_mfma_f32_16x16x32_bf16 v[20:23], a[180:183], v[52:55], v[20:23]
    s_add_u32 s57, s57, s58
    v_mfma_f32_16x16x32_bf16 v[20:23], a[196:199], v[56:59], v[20:23]
    s_add_u32 m0, s34, s36
    v_mfma_f32_16x16x32_bf16 v[24:27], a[168:171], v[48:51], v[24:27]
    s_add_u32 s36, s36, 18432
    v_mfma_f32_16x16x32_bf16 v[24:27], a[184:187], v[52:55], v[24:27]
    s_cmp_eq_u32 s36, 163840
    v_mfma_f32_16x16x32_bf16 v[24:27], a[200:203], v[56:59], v[24:27]
    s_cselect_b32 s36, 108544, s36
    v_mfma_f32_16x16x32_bf16 v[28:31], a[172:175], v[48:51], v[28:31]
    v_add_u32 v10, s36, v5
    v_mfma_f32_16x16x32_bf16 v[28:31], a[188:191], v[52:55], v[28:31]
    s_waitcnt vmcnt(10) lgkmcnt(0)
    v_mfma_f32_16x16x32_bf16 v[28:31], a[204:207], v[56:59], v[28:31]
    s_barrier
    v_mfma_f32_16x16x32_bf16 v[16:19], a[208:211], v[60:63], v[16:19]
    ds_read_b128 v[48:51], v10 offset:0
    v_mfma_f32_16x16x32_bf16 v[16:19], a[224:227], v[64:67], v[16:19]
    ds_read_b128 v[52:55], v10 offset:1024
    v_mfma_f32_16x16x32_bf16 v[32:35], a[240:243], v[68:71], v[16:19]
    ds_read_b128 v[56:59], v10 offset:2048
    v_mfma_f32_16x16x32_bf16 v[20:23], a[212:215], v[60:63], v[20:23]
    buffer_store_dword v12, v11, s[52:55], 0 offen sc1
    v_mfma_f32_16x16x32_bf16 v[20:23], a[228:231], v[64:67], v[20:23]
    v_add_u32 v12, 1, v12
    v_mfma_f32_16x16x32_bf16 v[36:39], a[244:247], v[68:71], v[20:23]
    s_lshr_b32 s58, s58, 1
    v_mfma_f32_16x16x32_bf16 v[24:27], a[216:219], v[60:63], v[24:27]
    s_add_u32 s62, s62, s58
    v_mfma_f32_16x16x32_bf16 v[24:27], a[232:235], v[64:67], v[24:27]
    s_cmp_lg_u32 s17, s14
    v_mfma_f32_16x16x32_bf16 v[40:43], a[248:251], v[68:71], v[24:27]
    v_mfma_f32_16x16x32_bf16 v[28:31], a[220:223], v[60:63], v[28:31]
    v_mfma_f32_16x16x32_bf16 v[28:31], a[236:239], v[64:67], v[28:31]
    s_waitcnt lgkmcnt(0)
    v_mfma_f32_16x16x32_bf16 v[44:47], a[252:255], v[68:71], v[28:31]
    s_cbranch_scc1 KP_loop1
    s_cmp_eq_u32 s17, 1
    s_cbranch_scc1 PG_9_go
KP_evt:

    s_waitcnt vmcnt(7)
    v_cmp_ne_u32 vcc, 1, v76
    buffer_store_dword v193, v191, s[20:23], 0 offen sc1
    s_and_b32 s14, s33, 31
    s_lshr_b32 s33, s33, 5
    s_cbranch_vccnz KP_d0s
KP_d0ok:
    v_mov_b32 v13, v196
    v_mov_b32 v196, v192
    v_mov_b32 v192, v190
    v_mov_b32 v191, v197
    v_mov_b32 v197, 2.0
    s_cmp_eq_u32 s17, s79
    s_cbranch_scc0 KP_loop1
    s_branch KP_bodyB
KP_xi:

    s_mov_b32 m0, s34
    s_mov_b32 s66, 1
    buffer_load_dwordx4 v5, s[44:47], s32 offen offset:0 sc1 lds
    buffer_load_dwordx4 v5, s[44:47], s32 offen offset:1024 sc1 lds
    buffer_load_dwordx4 v5, s[44:47], s32 offen offset:2048 sc1 lds
    buffer_load_dwordx4 v5, s[44:47], s32 offen offset:3072 sc1 lds
    buffer_load_dwordx4 v5, s[44:47], s32 offen offset:3584 sc1 lds
    s_add_u32 m0, s34, 18432
    s_add_u32 s32, s32, s39
    buffer_load_dwordx4 v5, s[44:47], s32 offen offset:0 sc1 lds
    buffer_load_dwordx4 v5, s[44:47], s32 offen offset:1024 sc1 lds
    buffer_load_dwordx4 v5, s[44:47], s32 offen offset:2048 sc1 lds
    buffer_load_dwordx4 v5, s[44:47], s32 offen offset:3072 sc1 lds
    buffer_load_dwordx4 v5, s[44:47], s32 offen offset:3584 sc1 lds
    s_add_u32 m0, s34, 36864
    s_add_u32 s32, s32, s39
    s_setpc_b64 s[82:83]
PG_bodyA:
    s_setpc_b64 s[82:83]
KP_bodyA:

    v_mfma_f32_16x16x32_bf16 v[16:19], v[224:227], v[48:51], 0
    ds_read_b128 v[60:63], v10 offset:3072
    v_mfma_f32_16x16x32_bf16 v[16:19], v[240:243], v[52:55], v[16:19]
    ds_read_b128 v[64:67], v10 offset:4096
    v_mfma_f32_16x16x32_bf16 v[16:19], a[0:3], v[56:59], v[16:19]
    ds_read_b128 v[68:71], v10 offset:5120
    v_mfma_f32_16x16x32_bf16 v[20:23], v[228:231], v[48:51], 0
    buffer_load_dwordx4 v5, s[44:47], s32 offen offset:0 sc1 lds
    v_mfma_f32_16x16x32_bf16 v[20:23], v[244:247], v[52:55], v[20:23]
    s_sub_u32 s17, s17, 1
    v_mfma_f32_16x16x32_bf16 v[20:23], a[4:7], v[56:59], v[20:23]
    s_mov_b64 s[64:65], s[80:81]
    v_mfma_f32_16x16x32_bf16 v[24:27], v[232:235], v[48:51], 0
    v_mfma_f32_16x16x32_bf16 v[24:27], v[248:251], v[52:55], v[24:27]
    buffer_load_dwordx4 v5, s[44:47], s32 offen offset:1024 sc1 lds
    v_mfma_f32_16x16x32_bf16 v[24:27], a[8:11], v[56:59], v[24:27]
    s_mov_b32 s66, 5308416
    v_mfma_f32_16x16x32_bf16 v[28:31], v[236:239], v[48:51], 0
    v_mfma_f32_16x16x32_bf16 v[28:31], v[252:255], v[52:55], v[28:31]
    buffer_load_dwordx4 v5, s[44:47], s32 offen offset:2048 sc1 lds
    s_add_u32 s35, s35, s38
    v_mfma_f32_16x16x32_bf16 v[28:31], a[12:15], v[56:59], v[28:31]
    s_waitcnt lgkmcnt(0)
    s_mov_b32 s42, 0x10000000
    v_mfma_f32_16x16x32_bf16 v[16:19], a[16:19], v[60:63], v[16:19]
    ds_read_b128 v[48:51], v10 offset:6144
    v_mfma_f32_16x16x32_bf16 v[16:19], a[32:35], v[64:67], v[16:19]
    ds_read_b128 v[52:55], v10 offset:7168
    v_mfma_f32_16x16x32_bf16 v[16:19], a[48:51], v[68:71], v[16:19]
    ds_read_b128 v[56:59], v10 offset:8192
    v_mfma_f32_16x16x32_bf16 v[20:23], a[20:23], v[60:63], v[20:23]
    buffer_load_dwordx4 v5, s[44:47], s32 offen offset:3072 sc1 lds
    v_mfma_f32_16x16x32_bf16 v[20:23], a[36:39], v[64:67], v[20:23]
    v_mfma_f32_16x16x32_bf16 v[20:23], a[52:55], v[68:71], v[20:23]
    v_mfma_f32_16x16x32_bf16 v[24:27], a[24:27], v[60:63], v[24:27]
    v_mfma_f32_16x16x32_bf16 v[24:27], a[40:43], v[64:67], v[24:27]
    buffer_load_dwordx4 v5, s[44:47], s32 offen offset:3584 sc1 lds
    v_mfma_f32_16x16x32_bf16 v[24:27], a[56:59], v[68:71], v[24:27]
    s_add_u32 s32, s32, s39
    v_mfma_f32_16x16x32_bf16 v[28:31], a[28:31], v[60:63], v[28:31]
    s_add_u32 m0, s59, 0
    v_mfma_f32_16x16x32_bf16 v[28:31], a[44:47], v[64:67], v[28:31]
    buffer_load_dwordx4 v5, s[64:67], s31 offen offset:0 nt lds
    v_mfma_f32_16x16x32_bf16 v[28:31], a[60:63], v[68:71], v[28:31]
    s_waitcnt lgkmcnt(0)
    v_mfma_f32_16x16x32_bf16 v[16:19], a[64:67], v[48:51], v[16:19]
    ds_read_b128 v[60:63], v10 offset:9216
    v_mfma_f32_16x16x32_bf16 v[16:19], a[80:83], v[52:55], v[16:19]
    ds_read_b128 v[64:67], v10 offset:10240
    v_mfma_f32_16x16x32_bf16 v[16:19], a[96:99], v[56:59], v[16:19]
    ds_read_b128 v[68:71], v10 offset:11264
    v_mfma_f32_16x16x32_bf16 v[20:23], a[68:71], v[48:51], v[20:23]
    buffer_load_dwordx4 v5, s[64:67], s31 offen offset:1024 nt lds
    v_mfma_f32_16x16x32_bf16 v[20:23], a[84:87], v[52:55], v[20:23]
    v_mfma_f32_16x16x32_bf16 v[20:23], a[100:103], v[56:59], v[20:23]
    v_mfma_f32_16x16x32_bf16 v[24:27], a[72:75], v[48:51], v[24:27]
    buffer_load_dwordx4 v5, s[64:67], s31 offen offset:2048 nt lds
    v_mfma_f32_16x16x32_bf16 v[24:27], a[88:91], v[52:55], v[24:27]
    v_mfma_f32_16x16x32_bf16 v[24:27], a[104:107], v[56:59], v[24:27]
    v_mfma_f32_16x16x32_bf16 v[28:31], a[76:79], v[48:51], v[28:31]
    buffer_load_dwordx4 v5, s[64:67], s31 offen offset:3072 nt lds
    s_add_u32 m0, s59, 4096
    v_mfma_f32_16x16x32_bf16 v[28:31], a[92:95], v[52:55], v[28:31]
    s_add_u32 s31, s31, 4096
    v_mfma_f32_16x16x32_bf16 v[28:31], a[108:111], v[56:59], v[28:31]
    s_waitcnt lgkmcnt(0)
    v_mfma_f32_16x16x32_bf16 v[16:19], a[112:115], v[60:63], v[16:19]
    ds_read_b128 v[48:51], v10 offset:12288
    v_mfma_f32_16x16x32_bf16 v[16:19], a[128:131], v[64:67], v[16:19]
    ds_read_b128 v[52:55], v10 offset:13312
    buffer_load_dwordx4 v5, s[64:67], s31 offen offset:0 nt lds
    v_mfma_f32_16x16x32_bf16 v[16:19], a[144:147], v[68:71], v[16:19]
    ds_read_b128 v[56:59], v10 offset:14336
    v_mfma_f32_16x16x32_bf16 v[20:23], a[116:119], v[60:63], v[20:23]
    v_mfma_f32_16x16x32_bf16 v[20:23], a[132:135], v[64:67], v[20:23]
    buffer_load_dwordx4 v5, s[64:67], s31 offen offset:1024 nt lds
    v_mfma_f32_16x16x32_bf16 v[20:23], a[148:151], v[68:71], v[20:23]
    v_mfma_f32_16x16x32_bf16 v[24:27], a[120:123], v[60:63], v[24:27]
    v_mfma_f32_16x16x32_bf16 v[24:27], a[136:139], v[64:67], v[24:27]
    buffer_load_dwordx4 v5, s[64:67], s31 offen offset:2048 nt lds
    v_mfma_f32_16x16x32_bf16 v[24:27], a[152:155], v[68:71], v[24:27]
    v_mfma_f32_16x16x32_bf16 v[28:31], a[124:127], v[60:63], v[28:31]
    v_mfma_f32_16x16x32_bf16 v[28:31], a[140:143], v[64:67], v[28:31]
    buffer_load_dwordx4 v5, s[64:67], s31 offen offset:3072 nt lds
    s_add_u32 m0, s59, 8192
    v_mfma_f32_16x16x32_bf16 v[28:31], a[156:159], v[68:71], v[28:31]
    s_waitcnt lgkmcnt(0)
    s_add_u32 s31, s31, 4096
    v_mfma_f32_16x16x32_bf16 v[16:19], a[160:163], v[48:51], v[16:19]
    ds_read_b128 v[60:63], v10 offset:15360
    v_mfma_f32_16x16x32_bf16 v[16:19], a[176:179], v[52:55], v[16:19]
    ds_read_b128 v[64:67], v10 offset:16384
    v_mfma_f32_16x16x32_bf16 v[16:19], a[192:195], v[56:59], v[16:19]
    ds_read_b128 v[68:71], v10 offset:17408
    v_mfma_f32_16x16x32_bf16 v[20:23], a[164:167], v[48:51], v[20:23]
    buffer_load_dwordx4 v5, s[64:67], s31 offen offset:0 nt lds
    v_mfma_f32_16x16x32_bf16 v[20:23], a[180:183], v[52:55], v[20:23]
    s_add_u32 m0, s34, s36
    v_mfma_f32_16x16x32_bf16 v[20:23], a[196:199], v[56:59], v[20:23]
    s_add_u32 s36, s36, 18432
    v_mfma_f32_16x16x32_bf16 v[24:27], a[168:171], v[48:51], v[24:27]
    s_cmp_eq_u32 s36, 163840
    v_mfma_f32_16x16x32_bf16 v[24:27], a[184:187], v[52:55], v[24:27]
    s_cselect_b32 s36, 108544, s36
    v_mfma_f32_16x16x32_bf16 v[24:27], a[200:203], v[56:59], v[24:27]
    v_add_u32 v10, s36, v5
    v_mfma_f32_16x16x32_bf16 v[28:31], a[172:175], v[48:51], v[28:31]
    v_mfma_f32_16x16x32_bf16 v[28:31], a[188:191], v[52:55], v[28:31]
    s_waitcnt vmcnt(14) lgkmcnt(0)
    v_mfma_f32_16x16x32_bf16 v[28:31], a[204:207], v[56:59], v[28:31]
    s_barrier
    v_mfma_f32_16x16x32_bf16 v[16:19], a[208:211], v[60:63], v[16:19]
    ds_read_b128 v[48:51], v10 offset:0
    v_mfma_f32_16x16x32_bf16 v[16:19], a[224:227], v[64:67], v[16:19]
    ds_read_b128 v[52:55], v10 offset:1024
    v_mfma_f32_16x16x32_bf16 v[32:35], a[240:243], v[68:71], v[16:19]
    ds_read_b128 v[56:59], v10 offset:2048
    v_mfma_f32_16x16x32_bf16 v[20:23], a[212:215], v[60:63], v[20:23]
    buffer_store_dword v12, v11, s[52:55], 0 offen sc1
    v_mfma_f32_16x16x32_bf16 v[20:23], a[228:231], v[64:67], v[20:23]
    v_add_u32 v12, 1, v12
    v_mfma_f32_16x16x32_bf16 v[36:39], a[244:247], v[68:71], v[20:23]
    s_mov_b64 s[64:65], s[4:5]
    v_mfma_f32_16x16x32_bf16 v[24:27], a[216:219], v[60:63], v[24:27]
    v_mfma_f32_16x16x32_bf16 v[24:27], a[232:235], v[64:67], v[24:27]
    v_mfma_f32_16x16x32_bf16 v[40:43], a[248:251], v[68:71], v[24:27]
    v_mfma_f32_16x16x32_bf16 v[28:31], a[220:223], v[60:63], v[28:31]
    v_mfma_f32_16x16x32_bf16 v[28:31], a[236:239], v[64:67], v[28:31]
    s_waitcnt lgkmcnt(0)
    v_mfma_f32_16x16x32_bf16 v[44:47], a[252:255], v[68:71], v[28:31]
    s_branch KP_loop1
PG_9_prev_end:
    .p2align 12
PG_9:
    s_setpc_b64 s[82:83]
PG_9_go:

    s_waitcnt vmcnt(7)
    v_cmp_lt_i32 vcc, v76, v15
    s_mov_b32 s46, 0x10000000
    s_cbranch_vccnz KP_p0s
KP_p0ok:
    v_mfma_f32_16x16x32_bf16 v[16:19], v[224:227], v[48:51], 0
    ds_read_b128 v[60:63], v10 offset:3072
    v_mov_b64 v[88:89], 0
    v_mfma_f32_16x16x32_bf16 v[16:19], v[240:243], v[52:55], v[16:19]
    ds_read_b128 v[64:67], v10 offset:4096
    v_mov_b64 v[86:87], 0
    v_mfma_f32_16x16x32_bf16 v[16:19], a[0:3], v[56:59], v[16:19]
    ds_read_b128 v[68:71], v10 offset:5120
    v_mov_b64 v[84:85], 0
    v_mfma_f32_16x16x32_bf16 v[20:23], v[228:231], v[48:51], 0
    buffer_load_dwordx4 v[152:155], v5, s[44:47], s74 offen offset:0 sc1
    v_mov_b64 v[82:83], 0
    v_mfma_f32_16x16x32_bf16 v[20:23], v[244:247], v[52:55], v[20:23]
    v_mov_b64 v[114:115], 0
    v_mov_b64 v[80:81], 0
    v_mfma_f32_16x16x32_bf16 v[20:23], a[4:7], v[56:59], v[20:23]
    v_mov_b64 v[112:113], 0
    v_mfma_f32_16x16x32_bf16 v[24:27], v[232:235], v[48:51], 0
    v_mov_b64 v[110:111], 0
    v_mfma_f32_16x16x32_bf16 v[24:27], v[248:251], v[52:55], v[24:27]
    v_mov_b64 v[108:109], 0
    v_mfma_f32_16x16x32_bf16 v[24:27], a[8:11], v[56:59], v[24:27]
    buffer_load_dwordx4 v[156:159], v5, s[44:47], s74 offen offset:1024 sc1
    s_add_u32 s74, s74, 131072
    v_mfma_f32_16x16x32_bf16 v[28:31], v[236:239], v[48:51], 0
    v_mul_f32 v32, v32, v40
    v_mul_f32 v33, v33, v41
    v_mfma_f32_16x16x32_bf16 v[28:31], v[252:255], v[52:55], v[28:31]
    v_mul_f32 v34, v34, v42
    v_mul_f32 v35, v35, v43
    v_mfma_f32_16x16x32_bf16 v[28:31], a[12:15], v[56:59], v[28:31]
    s_waitcnt lgkmcnt(0)
    v_mfma_f32_16x16x32_bf16 v[16:19], a[16:19], v[60:63], v[16:19]
    ds_read_b128 v[48:51], v10 offset:6144
    v_mfma_f32_16x16x32_bf16 v[16:19], a[32:35], v[64:67], v[16:19]
    ds_read_b128 v[52:55], v10 offset:7168
    v_mfma_f32_16x16x32_bf16 v[16:19], a[48:51], v[68:71], v[16:19]
    ds_read_b128 v[56:59], v10 offset:8192
    v_mfma_f32_16x16x32_bf16 v[20:23], a[20:23], v[60:63], v[20:23]
    buffer_load_dwordx4 v[160:163], v5, s[44:47], s74 offen offset:0 sc1
    v_mfma_f32_16x16x32_bf16 v[20:23], a[36:39], v[64:67], v[20:23]
    v_cvt_pk_bf16_f32 v72, v32, v33
    v_mfma_f32_16x16x32_bf16 v[20:23], a[52:55], v[68:71], v[20:23]
    v_cvt_pk_bf16_f32 v73, v34, v35
    v_mfma_f32_16x16x32_bf16 v[24:27], a[24:27], v[60:63], v[24:27]
    v_mul_f32 v36, v36, v44
    v_mfma_f32_16x16x32_bf16 v[24:27], a[40:43], v[64:67], v[24:27]
    v_mul_f32 v37, v37, v45
    v_mfma_f32_16x16x32_bf16 v[24:27], a[56:59], v[68:71], v[24:27]
    v_mov_b64 v[106:107], 0
    v_mfma_f32_16x16x32_bf16 v[28:31], a[28:31], v[60:63], v[28:31]
    buffer_load_dwordx4 v[164:167], v5, s[44:47], s74 offen offset:1024 sc1
    s_add_u32 s74, s74, 131072
    v_mfma_f32_16x16x32_bf16 v[28:31], a[44:47], v[64:67], v[28:31]
    v_mul_f32 v38, v38, v46
    v_mul_f32 v39, v39, v47
    v_mfma_f32_16x16x32_bf16 v[28:31], a[60:63], v[68:71], v[28:31]
    s_waitcnt lgkmcnt(0)
    v_cvt_pk_bf16_f32 v74, v36, v37
    v_mfma_f32_16x16x32_bf16 v[16:19], a[64:67], v[48:51], v[16:19]
    ds_read_b128 v[60:63], v10 offset:9216
    v_mfma_f32_16x16x32_bf16 v[16:19], a[80:83], v[52:55], v[16:19]
    ds_read_b128 v[64:67], v10 offset:10240
    v_mfma_f32_16x16x32_bf16 v[16:19], a[96:99], v[56:59], v[16:19]
    ds_read_b128 v[68:71], v10 offset:11264
    v_mfma_f32_16x16x32_bf16 v[20:23], a[68:71], v[48:51], v[20:23]
    v_cvt_pk_bf16_f32 v75, v38, v39
    v_mfma_f32_16x16x32_bf16 v[20:23], a[84:87], v[52:55], v[20:23]
    buffer_store_dwordx4 v[72:75], v5, s[40:43], s35 offen sc1
    v_mfma_f32_16x16x32_bf16 v[20:23], a[100:103], v[56:59], v[20:23]
    s_add_u32 s35, s35, s38
    v_mfma_f32_16x16x32_bf16 v[24:27], a[72:75], v[48:51], v[24:27]
    v_mov_b64 v[104:105], 0
    v_mfma_f32_16x16x32_bf16 v[24:27], a[88:91], v[52:55], v[24:27]
    v_mov_b64 v[102:103], 0
    v_mfma_f32_16x16x32_bf16 v[24:27], a[104:107], v[56:59], v[24:27]
    v_mov_b64 v[100:101], 0
    v_mfma_f32_16x16x32_bf16 v[28:31], a[76:79], v[48:51], v[28:31]
    buffer_load_dwordx4 v[168:171], v5, s[44:47], s74 offen offset:0 sc1
    v_mfma_f32_16x16x32_bf16 v[28:31], a[92:95], v[52:55], v[28:31]
    v_mov_b64 v[98:99], 0
    v_mfma_f32_16x16x32_bf16 v[28:31], a[108:111], v[56:59], v[28:31]
    s_waitcnt lgkmcnt(0)
    v_mfma_f32_16x16x32_bf16 v[16:19], a[112:115], v[60:63], v[16:19]
    ds_read_b128 v[48:51], v10 offset:12288
    v_mfma_f32_16x16x32_bf16 v[16:19], a[128:131], v[64:67], v[16:19]
    ds_read_b128 v[52:55], v10 offset:13312
    v_mfma_f32_16x16x32_bf16 v[16:19], a[144:147], v[68:71], v[16:19]
    ds_read_b128 v[56:59], v10 offset:14336
    v_mfma_f32_16x16x32_bf16 v[20:23], a[116:119], v[60:63], v[20:23]
    buffer_load_dwordx4 v[172:175], v5, s[44:47], s74 offen offset:1024 sc1
    v_mfma_f32_16x16x32_bf16 v[20:23], a[132:135], v[64:67], v[20:23]
    s_add_u32 s74, s74, 131072
    v_mfma_f32_16x16x32_bf16 v[20:23], a[148:151], v[68:71], v[20:23]
    v_mov_b64 v[96:97], 0
    v_mfma_f32_16x16x32_bf16 v[24:27], a[120:123], v[60:63], v[24:27]
    v_mov_b64 v[94:95], 0
    v_mfma_f32_16x16x32_bf16 v[24:27], a[136:139], v[64:67], v[24:27]
    v_mov_b64 v[92:93], 0
    v_mfma_f32_16x16x32_bf16 v[24:27], a[152:155], v[68:71], v[24:27]
    buffer_load_dwordx4 v[176:179], v5, s[44:47], s74 offen offset:0 sc1
    s_add_u32 s36, s36, 18432
    v_mfma_f32_16x16x32_bf16 v[28:31], a[124:127], v[60:63], v[28:31]
    s_cmp_eq_u32 s36, 163840
    v_mfma_f32_16x16x32_bf16 v[28:31], a[140:143], v[64:67], v[28:31]
    s_cselect_b32 s36, 108544, s36
    v_mfma_f32_16x16x32_bf16 v[28:31], a[156:159], v[68:71], v[28:31]
    s_waitcnt lgkmcnt(0)
    v_mfma_f32_16x16x32_bf16 v[16:19], a[160:163], v[48:51], v[16:19]
    ds_read_b128 v[60:63], v10 offset:15360
    v_mfma_f32_16x16x32_bf16 v[16:19], a[176:179], v[52:55], v[16:19]
    ds_read_b128 v[64:67], v10 offset:16384
    v_mfma_f32_16x16x32_bf16 v[16:19], a[192:195], v[56:59], v[16:19]
    ds_read_b128 v[68:71], v10 offset:17408
    v_mfma_f32_16x16x32_bf16 v[20:23], a[164:167], v[48:51], v[20:23]
    buffer_load_dwordx4 v[180:183], v5, s[44:47], s74 offen offset:1024 sc1
    v_mfma_f32_16x16x32_bf16 v[20:23], a[180:183], v[52:55], v[20:23]
    s_add_u32 s74, s74, 655360
    v_mfma_f32_16x16x32_bf16 v[20:23], a[196:199], v[56:59], v[20:23]
    s_cmp_ge_u32 s74, s75
    v_mfma_f32_16x16x32_bf16 v[24:27], a[168:171], v[48:51], v[24:27]
    s_cselect_b32 s30, 4718592, 0
    v_mfma_f32_16x16x32_bf16 v[24:27], a[184:187], v[52:55], v[24:27]
    s_sub_u32 s74, s74, s30
    v_mfma_f32_16x16x32_bf16 v[24:27], a[200:203], v[56:59], v[24:27]
    v_add_u32 v10, s36, v5
    v_mfma_f32_16x16x32_bf16 v[28:31], a[172:175], v[48:51], v[28:31]
    v_mov_b64 v[90:91], 0
    v_mfma_f32_16x16x32_bf16 v[28:31], a[188:191], v[52:55], v[28:31]
    s_waitcnt vmcnt(11) lgkmcnt(0)
    v_mfma_f32_16x16x32_bf16 v[28:31], a[204:207], v[56:59], v[28:31]
    s_barrier
    v_mfma_f32_16x16x32_bf16 v[16:19], a[208:211], v[60:63], v[16:19]
    ds_read_b128 v[48:51], v10 offset:0
    v_mfma_f32_16x16x32_bf16 v[16:19], a[224:227], v[64:67], v[16:19]
    ds_read_b128 v[52:55], v10 offset:1024
    v_mfma_f32_16x16x32_bf16 v[32:35], a[240:243], v[68:71], v[16:19]
    ds_read_b128 v[56:59], v10 offset:2048
    v_mfma_f32_16x16x32_bf16 v[20:23], a[212:215], v[60:63], v[20:23]
    buffer_store_dword v12, v11, s[52:55], 0 offen sc1
    v_mfma_f32_16x16x32_bf16 v[20:23], a[228:231], v[64:67], v[20:23]
    v_add_u32 v12, 1, v12
    v_mfma_f32_16x16x32_bf16 v[36:39], a[244:247], v[68:71], v[20:23]
    v_mfma_f32_16x16x32_bf16 v[24:27], a[216:219], v[60:63], v[24:27]
    v_mfma_f32_16x16x32_bf16 v[24:27], a[232:235], v[64:67], v[24:27]
    v_mfma_f32_16x16x32_bf16 v[40:43], a[248:251], v[68:71], v[24:27]
    v_mfma_f32_16x16x32_bf16 v[28:31], a[220:223], v[60:63], v[28:31]
    v_mfma_f32_16x16x32_bf16 v[28:31], a[236:239], v[64:67], v[28:31]
    v_mfma_f32_16x16x32_bf16 v[44:47], a[252:255], v[68:71], v[28:31]
    s_waitcnt lgkmcnt(0)
    v_mfma_f32_16x16x32_bf16 v[16:19], v[224:227], v[48:51], 0
    ds_read_b128 v[60:63], v10 offset:3072
    v_mov_b64 v[118:119], 0
    v_mfma_f32_16x16x32_bf16 v[16:19], v[240:243], v[52:55], v[16:19]
    ds_read_b128 v[64:67], v10 offset:4096
    v_mov_b64 v[116:117], 0
    v_mfma_f32_16x16x32_bf16 v[16:19], a[0:3], v[56:59], v[16:19]
    ds_read_b128 v[68:71], v10 offset:5120
    v_mfma_f32_16x16x32_bf16 v[20:23], v[228:231], v[48:51], 0
    buffer_load_dwordx4 v[184:187], v5, s[44:47], s74 offen offset:0 sc1
    v_mfma_f32_16x16x32_bf16 v[20:23], v[244:247], v[52:55], v[20:23]
    v_mov_b64 v[150:151], 0
    v_mfma_f32_16x16x32_bf16 v[20:23], a[4:7], v[56:59], v[20:23]
    v_mov_b64 v[148:149], 0
    v_mfma_f32_16x16x32_bf16 v[24:27], v[232:235], v[48:51], 0
    v_mov_b64 v[146:147], 0
    v_mfma_f32_16x16x32_bf16 v[24:27], v[248:251], v[52:55], v[24:27]
    v_mov_b64 v[144:145], 0
    v_mfma_f32_16x16x32_bf16 v[24:27], a[8:11], v[56:59], v[24:27]
    buffer_load_dwordx4 v[188:191], v5, s[44:47], s74 offen offset:1024 sc1
    s_add_u32 s74, s74, 131072
    v_mfma_f32_16x16x32_bf16 v[28:31], v[236:239], v[48:51], 0
    v_mul_f32 v32, v32, v40
    v_mul_f32 v33, v33, v41
    v_mfma_f32_16x16x32_bf16 v[28:31], v[252:255], v[52:55], v[28:31]
    v_mul_f32 v34, v34, v42
    v_mul_f32 v35, v35, v43
    v_mfma_f32_16x16x32_bf16 v[28:31], a[12:15], v[56:59], v[28:31]
    s_waitcnt lgkmcnt(0)
    v_mfma_f32_16x16x32_bf16 v[16:19], a[16:19], v[60:63], v[16:19]
    ds_read_b128 v[48:51], v10 offset:6144
    v_mfma_f32_16x16x32_bf16 v[16:19], a[32:35], v[64:67], v[16:19]
    ds_read_b128 v[52:55], v10 offset:7168
    v_mfma_f32_16x16x32_bf16 v[16:19], a[48:51], v[68:71], v[16:19]
    ds_read_b128 v[56:59], v10 offset:8192
    v_mfma_f32_16x16x32_bf16 v[20:23], a[20:23], v[60:63], v[20:23]
    buffer_load_dwordx4 v[192:195], v5, s[44:47], s74 offen offset:0 sc1
    v_mfma_f32_16x16x32_bf16 v[20:23], a[36:39], v[64:67], v[20:23]
    v_cvt_pk_bf16_f32 v72, v32, v33
    v_mfma_f32_16x16x32_bf16 v[20:23], a[52:55], v[68:71], v[20:23]
    v_cvt_pk_bf16_f32 v73, v34, v35
    v_mfma_f32_16x16x32_bf16 v[24:27], a[24:27], v[60:63], v[24:27]
    v_mul_f32 v36, v36, v44
    v_mfma_f32_16x16x32_bf16 v[24:27], a[40:43], v[64:67], v[24:27]
    v_mul_f32 v37, v37, v45
    v_mfma_f32_16x16x32_bf16 v[24:27], a[56:59], v[68:71], v[24:27]
    v_mov_b64 v[142:143], 0
    v_mfma_f32_16x16x32_bf16 v[28:31], a[28:31], v[60:63], v[28:31]
    buffer_load_dwordx4 v[196:199], v5, s[44:47], s74 offen offset:1024 sc1
    s_add_u32 s74, s74, 131072
    v_mfma_f32_16x16x32_bf16 v[28:31], a[44:47], v[64:67], v[28:31]
    v_mul_f32 v38, v38, v46
    v_mul_f32 v39, v39, v47
    v_mfma_f32_16x16x32_bf16 v[28:31], a[60:63], v[68:71], v[28:31]
    s_waitcnt lgkmcnt(0)
    v_cvt_pk_bf16_f32 v74, v36, v37
    v_mfma_f32_16x16x32_bf16 v[16:19], a[64:67], v[48:51], v[16:19]
    ds_read_b128 v[60:63], v10 offset:9216
    v_mfma_f32_16x16x32_bf16 v[16:19], a[80:83], v[52:55], v[16:19]
    ds_read_b128 v[64:67], v10 offset:10240
    v_mfma_f32_16x16x32_bf16 v[16:19], a[96:99], v[56:59], v[16:19]
    ds_read_b128 v[68:71], v10 offset:11264
    v_mfma_f32_16x16x32_bf16 v[20:23], a[68:71], v[48:51], v[20:23]
    v_cvt_pk_bf16_f32 v75, v38, v39
    v_mfma_f32_16x16x32_bf16 v[20:23], a[84:87], v[52:55], v[20:23]
    buffer_store_dwordx4 v[72:75], v5, s[40:43], s35 offen sc1
    v_mfma_f32_16x16x32_bf16 v[20:23], a[100:103], v[56:59], v[20:23]
    s_add_u32 s35, s35, s38
    v_mfma_f32_16x16x32_bf16 v[24:27], a[72:75], v[48:51], v[24:27]
    v_mov_b64 v[140:141], 0
    v_mfma_f32_16x16x32_bf16 v[24:27], a[88:91], v[52:55], v[24:27]
    v_mov_b64 v[138:139], 0
    v_mfma_f32_16x16x32_bf16 v[24:27], a[104:107], v[56:59], v[24:27]
    v_mov_b64 v[136:137], 0
    v_mfma_f32_16x16x32_bf16 v[28:31], a[76:79], v[48:51], v[28:31]
    buffer_load_dwordx4 v[200:203], v5, s[44:47], s74 offen offset:0 sc1
    v_mfma_f32_16x16x32_bf16 v[28:31], a[92:95], v[52:55], v[28:31]
    v_mov_b64 v[134:135], 0
    v_mfma_f32_16x16x32_bf16 v[28:31], a[108:111], v[56:59], v[28:31]
    s_waitcnt lgkmcnt(0)
    v_mfma_f32_16x16x32_bf16 v[16:19], a[112:115], v[60:63], v[16:19]
    ds_read_b128 v[48:51], v10 offset:12288
    v_mfma_f32_16x16x32_bf16 v[16:19], a[128:131], v[64:67], v[16:19]
    ds_read_b128 v[52:55], v10 offset:13312
    v_mfma_f32_16x16x32_bf16 v[16:19], a[144:147], v[68:71], v[16:19]
    ds_read_b128 v[56:59], v10 offset:14336
    v_mfma_f32_16x16x32_bf16 v[20:23], a[116:119], v[60:63], v[20:23]
    buffer_load_dwordx4 v[204:207], v5, s[44:47], s74 offen offset:1024 sc1
    v_mfma_f32_16x16x32_bf16 v[20:23], a[132:135], v[64:67], v[20:23]
    s_add_u32 s74, s74, 131072
    v_mfma_f32_16x16x32_bf16 v[20:23], a[148:151], v[68:71], v[20:23]
    v_mov_b64 v[132:133], 0
    v_mfma_f32_16x16x32_bf16 v[24:27], a[120:123], v[60:63], v[24:27]
    v_mov_b64 v[130:131], 0
    v_mfma_f32_16x16x32_bf16 v[24:27], a[136:139], v[64:67], v[24:27]
    v_mov_b64 v[128:129], 0
    v_mfma_f32_16x16x32_bf16 v[24:27], a[152:155], v[68:71], v[24:27]
    buffer_load_dwordx4 v[208:211], v5, s[44:47], s74 offen offset:0 sc1
    v_mfma_f32_16x16x32_bf16 v[28:31], a[124:127], v[60:63], v[28:31]
    v_mov_b64 v[126:127], 0
    v_mfma_f32_16x16x32_bf16 v[28:31], a[140:143], v[64:67], v[28:31]
    v_mov_b64 v[124:125], 0
    v_mfma_f32_16x16x32_bf16 v[28:31], a[156:159], v[68:71], v[28:31]
    s_waitcnt lgkmcnt(0)
    v_mfma_f32_16x16x32_bf16 v[16:19], a[160:163], v[48:51], v[16:19]
    ds_read_b128 v[60:63], v10 offset:15360
    v_mfma_f32_16x16x32_bf16 v[16:19], a[176:179], v[52:55], v[16:19]
    ds_read_b128 v[64:67], v10 offset:16384
    v_mfma_f32_16x16x32_bf16 v[16:19], a[192:195], v[56:59], v[16:19]
    ds_read_b128 v[68:71], v10 offset:17408
    v_mfma_f32_16x16x32_bf16 v[20:23], a[164:167], v[48:51], v[20:23]
    buffer_load_dwordx4 v[212:215], v5, s[44:47], s74 offen offset:1024 sc1
    v_mfma_f32_16x16x32_bf16 v[20:23], a[180:183], v[52:55], v[20:23]
    s_add_u32 s74, s74, 655360
    v_mfma_f32_16x16x32_bf16 v[20:23], a[196:199], v[56:59], v[20:23]
    s_cmp_ge_u32 s74, s75
    v_mfma_f32_16x16x32_bf16 v[24:27], a[168:171], v[48:51], v[24:27]
    s_cselect_b32 s30, 4718592, 0
    v_mfma_f32_16x16x32_bf16 v[24:27], a[184:187], v[52:55], v[24:27]
    s_sub_u32 s74, s74, s30
    v_mfma_f32_16x16x32_bf16 v[24:27], a[200:203], v[56:59], v[24:27]
    v_mov_b64 v[122:123], 0
    v_mfma_f32_16x16x32_bf16 v[28:31], a[172:175], v[48:51], v[28:31]
    v_mov_b64 v[120:121], 0
    v_mfma_f32_16x16x32_bf16 v[28:31], a[188:191], v[52:55], v[28:31]
    s_waitcnt vmcnt(14) lgkmcnt(0)
    v_mfma_f32_16x16x32_bf16 v[28:31], a[204:207], v[56:59], v[28:31]
    s_barrier
    v_mfma_f32_16x16x32_bf16 v[16:19], a[208:211], v[60:63], v[16:19]
    ds_read_b128 a[0:3], v5 offset:0
    v_mfma_f32_16x16x32_bf16 v[16:19], a[224:227], v[64:67], v[16:19]
    ds_read_b128 a[4:7], v5 offset:1024
    buffer_store_dword v12, v11, s[52:55], 0 offen sc1
    v_mfma_f32_16x16x32_bf16 v[32:35], a[240:243], v[68:71], v[16:19]
    ds_read_b128 a[8:11], v5 offset:2048
    s_add_u32 m0, s59, 73728
    v_mfma_f32_16x16x32_bf16 v[20:23], a[212:215], v[60:63], v[20:23]
    ds_read_b128 a[12:15], v5 offset:3072
    v_mfma_f32_16x16x32_bf16 v[20:23], a[228:231], v[64:67], v[20:23]
    ds_read_b128 a[16:19], v5 offset:4096
    v_mfma_f32_16x16x32_bf16 v[36:39], a[244:247], v[68:71], v[20:23]
    ds_read_b128 a[20:23], v5 offset:5120
    v_mfma_f32_16x16x32_bf16 v[24:27], a[216:219], v[60:63], v[24:27]
    ds_read_b128 a[24:27], v5 offset:6144
    buffer_load_dwordx4 v5, s[24:27], s60 offen offset:0 sc1 lds
    v_mfma_f32_16x16x32_bf16 v[24:27], a[232:235], v[64:67], v[24:27]
    ds_read_b128 a[28:31], v5 offset:7168
    v_mfma_f32_16x16x32_bf16 v[40:43], a[248:251], v[68:71], v[24:27]
    v_mfma_f32_16x16x32_bf16 v[28:31], a[220:223], v[60:63], v[28:31]
    v_mfma_f32_16x16x32_bf16 v[28:31], a[236:239], v[64:67], v[28:31]
    buffer_load_dwordx4 v5, s[24:27], s60 offen offset:1024 sc1 lds
    v_mfma_f32_16x16x32_bf16 v[44:47], a[252:255], v[68:71], v[28:31]
    v_mov_b32 v77, 32
    s_nop 2
    v_mul_f32 v32, v32, v40
    v_mul_f32 v33, v33, v41
    v_mul_f32 v34, v34, v42
    v_mul_f32 v35, v35, v43
    v_cvt_pk_bf16_f32 v72, v32, v33
    v_cvt_pk_bf16_f32 v73, v34, v35
    v_mul_f32 v36, v36, v44
    v_mul_f32 v37, v37, v45
    v_mul_f32 v38, v38, v46
    v_mul_f32 v39, v39, v47
    v_cvt_pk_bf16_f32 v74, v36, v37
    v_cvt_pk_bf16_f32 v75, v38, v39
    buffer_store_dwordx4 v[72:75], v5, s[40:43], s35 offen sc1
    s_branch PG_6_go
PG_bodyB:
    s_setpc_b64 s[82:83]
KP_bodyB:

    v_mfma_f32_16x16x32_bf16 v[16:19], v[224:227], v[48:51], 0
    ds_read_b128 v[60:63], v10 offset:3072
    v_mfma_f32_16x16x32_bf16 v[16:19], v[240:243], v[52:55], v[16:19]
    ds_read_b128 v[64:67], v10 offset:4096
    v_mfma_f32_16x16x32_bf16 v[16:19], a[0:3], v[56:59], v[16:19]
    ds_read_b128 v[68:71], v10 offset:5120
    v_mfma_f32_16x16x32_bf16 v[20:23], v[228:231], v[48:51], 0
    ds_read_b64_tr_b16 v[152:153], v189 offset:0
    buffer_load_dwordx4 v5, s[44:47], s32 offen offset:0 sc1 lds
    v_mfma_f32_16x16x32_bf16 v[20:23], v[244:247], v[52:55], v[20:23]
    ds_read_b64_tr_b16 v[154:155], v189 offset:18432
    v_mfma_f32_16x16x32_bf16 v[20:23], a[4:7], v[56:59], v[20:23]
    ds_read_b64_tr_b16 v[156:157], v198 offset:0
    v_mfma_f32_16x16x32_bf16 v[24:27], v[232:235], v[48:51], 0
    ds_read_b64_tr_b16 v[158:159], v198 offset:18432
    v_mfma_f32_16x16x32_bf16 v[24:27], v[248:251], v[52:55], v[24:27]
    s_sub_u32 s17, s17, 1
    v_mfma_f32_16x16x32_bf16 v[24:27], a[8:11], v[56:59], v[24:27]
    buffer_load_dwordx4 v5, s[44:47], s32 offen offset:1024 sc1 lds
    v_mul_f32 v32, v32, v40
    v_mfma_f32_16x16x32_bf16 v[28:31], v[236:239], v[48:51], 0
    v_mul_f32 v33, v33, v41
    v_mfma_f32_16x16x32_bf16 v[28:31], v[252:255], v[52:55], v[28:31]
    v_mul_f32 v34, v34, v42
    v_mfma_f32_16x16x32_bf16 v[28:31], a[12:15], v[56:59], v[28:31]
    s_waitcnt lgkmcnt(0)
    v_mfma_f32_16x16x32_bf16 v[16:19], a[16:19], v[60:63], v[16:19]
    ds_read_b128 v[48:51], v10 offset:6144
    buffer_load_dwordx4 v5, s[44:47], s32 offen offset:2048 sc1 lds
    v_mfma_f32_16x16x32_bf16 v[16:19], a[32:35], v[64:67], v[16:19]
    ds_read_b128 v[52:55], v10 offset:7168
    v_mul_f32 v35, v35, v43
    v_mfma_f32_16x16x32_bf16 v[16:19], a[48:51], v[68:71], v[16:19]
    ds_read_b128 v[56:59], v10 offset:8192
    v_cvt_pk_bf16_f32 v72, v32, v33
    v_mfma_f32_16x16x32_bf16 v[20:23], a[20:23], v[60:63], v[20:23]
    ds_read_b64_tr_b16 v[160:161], v198 offset:8
    buffer_store_dwordx4 v[152:155], v5, s[20:23], s63 offen sc1
    v_mfma_f32_16x16x32_bf16 v[20:23], a[36:39], v[64:67], v[20:23]
    ds_read_b64_tr_b16 v[162:163], v198 offset:18440
    s_add_u32 s63, s63, 4096
    v_mfma_f32_16x16x32_bf16 v[20:23], a[52:55], v[68:71], v[20:23]
    ds_read_b64_tr_b16 v[164:165], v199 offset:0
    v_cvt_pk_bf16_f32 v73, v34, v35
    v_mfma_f32_16x16x32_bf16 v[24:27], a[24:27], v[60:63], v[24:27]
    ds_read_b64_tr_b16 v[166:167], v199 offset:18432
    v_mul_f32 v36, v36, v44
    v_mfma_f32_16x16x32_bf16 v[24:27], a[40:43], v[64:67], v[24:27]
    buffer_load_dwordx4 v5, s[44:47], s32 offen offset:3072 sc1 lds
    v_mfma_f32_16x16x32_bf16 v[24:27], a[56:59], v[68:71], v[24:27]
    v_mul_f32 v37, v37, v45
    v_mfma_f32_16x16x32_bf16 v[28:31], a[28:31], v[60:63], v[28:31]
    v_mul_f32 v38, v38, v46
    v_mfma_f32_16x16x32_bf16 v[28:31], a[44:47], v[64:67], v[28:31]
    buffer_store_dwordx4 v[156:159], v5, s[20:23], s63 offen sc1
    s_add_u32 s63, s63, 4096
    v_mfma_f32_16x16x32_bf16 v[28:31], a[60:63], v[68:71], v[28:31]
    s_waitcnt lgkmcnt(0)
    v_mul_f32 v39, v39, v47
    v_mfma_f32_16x16x32_bf16 v[16:19], a[64:67], v[48:51], v[16:19]
    ds_read_b128 v[60:63], v10 offset:9216
    v_cvt_pk_bf16_f32 v74, v36, v37
    v_mfma_f32_16x16x32_bf16 v[16:19], a[80:83], v[52:55], v[16:19]
    ds_read_b128 v[64:67], v10 offset:10240
    buffer_load_dwordx4 v5, s[44:47], s32 offen offset:3584 sc1 lds
    v_mfma_f32_16x16x32_bf16 v[16:19], a[96:99], v[56:59], v[16:19]
    ds_read_b128 v[68:71], v10 offset:11264
    v_cvt_pk_bf16_f32 v75, v38, v39
    v_mfma_f32_16x16x32_bf16 v[20:23], a[68:71], v[48:51], v[20:23]
    ds_read_b64_tr_b16 v[168:169], v199 offset:8
    v_mfma_f32_16x16x32_bf16 v[20:23], a[84:87], v[52:55], v[20:23]
    ds_read_b64_tr_b16 v[170:171], v199 offset:18440
    buffer_store_dwordx4 v[160:163], v5, s[20:23], s63 offen sc1
    v_mfma_f32_16x16x32_bf16 v[20:23], a[100:103], v[56:59], v[20:23]
    ds_read_b64_tr_b16 v[172:173], v200 offset:0
    s_add_u32 s63, s63, 4096
    v_mfma_f32_16x16x32_bf16 v[24:27], a[72:75], v[48:51], v[24:27]
    ds_read_b64_tr_b16 v[174:175], v200 offset:18432
    v_mfma_f32_16x16x32_bf16 v[24:27], a[88:91], v[52:55], v[24:27]
    buffer_store_dwordx4 v[72:75], v5, s[40:43], s35 offen sc1
    v_mfma_f32_16x16x32_bf16 v[24:27], a[104:107], v[56:59], v[24:27]
    s_add_u32 s35, s35, s38
    v_mfma_f32_16x16x32_bf16 v[28:31], a[76:79], v[48:51], v[28:31]
    v_mfma_f32_16x16x32_bf16 v[28:31], a[92:95], v[52:55], v[28:31]
    buffer_store_dwordx4 v[164:167], v5, s[20:23], s63 offen sc1
    s_add_u32 s63, s63, 4096
    v_mfma_f32_16x16x32_bf16 v[28:31], a[108:111], v[56:59], v[28:31]
    s_waitcnt lgkmcnt(0)
    s_add_u32 s32, s32, s39
    v_mfma_f32_16x16x32_bf16 v[16:19], a[112:115], v[60:63], v[16:19]
    ds_read_b128 v[48:51], v10 offset:12288
    v_mfma_f32_16x16x32_bf16 v[16:19], a[128:131], v[64:67], v[16:19]
    ds_read_b128 v[52:55], v10 offset:13312
    v_mfma_f32_16x16x32_bf16 v[16:19], a[144:147], v[68:71], v[16:19]
    ds_read_b128 v[56:59], v10 offset:14336
    v_mfma_f32_16x16x32_bf16 v[20:23], a[116:119], v[60:63], v[20:23]
    ds_read_b64_tr_b16 v[176:177], v200 offset:8
    buffer_store_dwordx4 v[168:171], v5, s[20:23], s63 offen sc1
    v_mfma_f32_16x16x32_bf16 v[20:23], a[132:135], v[64:67], v[20:23]
    ds_read_b64_tr_b16 v[178:179], v200 offset:18440
    v_mfma_f32_16x16x32_bf16 v[20:23], a[148:151], v[68:71], v[20:23]
    ds_read_b64_tr_b16 v[180:181], v201 offset:0
    v_mfma_f32_16x16x32_bf16 v[24:27], a[120:123], v[60:63], v[24:27]
    ds_read_b64_tr_b16 v[182:183], v201 offset:18432
    v_mfma_f32_16x16x32_bf16 v[24:27], a[136:139], v[64:67], v[24:27]
    s_add_u32 s63, s63, 4096
    v_mfma_f32_16x16x32_bf16 v[24:27], a[152:155], v[68:71], v[24:27]
    buffer_store_dwordx4 v[172:175], v5, s[20:23], s63 offen sc1
    v_mfma_f32_16x16x32_bf16 v[28:31], a[124:127], v[60:63], v[28:31]
    s_add_u32 s63, s63, 4096
    v_mfma_f32_16x16x32_bf16 v[28:31], a[140:143], v[64:67], v[28:31]
    v_mfma_f32_16x16x32_bf16 v[28:31], a[156:159], v[68:71], v[28:31]
    s_waitcnt lgkmcnt(0)
    v_mfma_f32_16x16x32_bf16 v[16:19], a[160:163], v[48:51], v[16:19]
    ds_read_b128 v[60:63], v10 offset:15360
    buffer_store_dwordx4 v[176:179], v5, s[20:23], s63 offen sc1
    v_mfma_f32_16x16x32_bf16 v[16:19], a[176:179], v[52:55], v[16:19]
    ds_read_b128 v[64:67], v10 offset:16384
    s_add_u32 s63, s63, 4096
    v_mfma_f32_16x16x32_bf16 v[16:19], a[192:195], v[56:59], v[16:19]
    ds_read_b128 v[68:71], v10 offset:17408
    s_add_u32 m0, s34, s36
    v_mfma_f32_16x16x32_bf16 v[20:23], a[164:167], v[48:51], v[20:23]
    ds_read_b64_tr_b16 v[184:185], v201 offset:8
    s_add_u32 s36, s36, 18432
    v_mfma_f32_16x16x32_bf16 v[20:23], a[180:183], v[52:55], v[20:23]
    ds_read_b64_tr_b16 v[186:187], v201 offset:18440
    s_cmp_eq_u32 s36, 163840
    v_mfma_f32_16x16x32_bf16 v[20:23], a[196:199], v[56:59], v[20:23]
    buffer_store_dwordx4 v[180:183], v5, s[20:23], s63 offen sc1
    v_mfma_f32_16x16x32_bf16 v[24:27], a[168:171], v[48:51], v[24:27]
    s_cselect_b32 s36, 108544, s36
    v_mfma_f32_16x16x32_bf16 v[24:27], a[184:187], v[52:55], v[24:27]
    v_add_u32 v10, s36, v5
    v_mfma_f32_16x16x32_bf16 v[24:27], a[200:203], v[56:59], v[24:27]
    s_add_u32 s63, s63, 4096
    v_mfma_f32_16x16x32_bf16 v[28:31], a[172:175], v[48:51], v[28:31]
    v_mfma_f32_16x16x32_bf16 v[28:31], a[188:191], v[52:55], v[28:31]
    s_waitcnt vmcnt(19) lgkmcnt(0)
    v_mfma_f32_16x16x32_bf16 v[28:31], a[204:207], v[56:59], v[28:31]
    s_barrier
    v_mfma_f32_16x16x32_bf16 v[16:19], a[208:211], v[60:63], v[16:19]
    ds_read_b128 v[48:51], v10 offset:0
    v_mfma_f32_16x16x32_bf16 v[16:19], a[224:227], v[64:67], v[16:19]
    ds_read_b128 v[52:55], v10 offset:1024
    v_mfma_f32_16x16x32_bf16 v[32:35], a[240:243], v[68:71], v[16:19]
    ds_read_b128 v[56:59], v10 offset:2048
    v_mfma_f32_16x16x32_bf16 v[20:23], a[212:215], v[60:63], v[20:23]
    buffer_store_dword v12, v11, s[52:55], 0 offen sc1
    v_mfma_f32_16x16x32_bf16 v[20:23], a[228:231], v[64:67], v[20:23]
    v_add_u32 v12, 1, v12
    v_mfma_f32_16x16x32_bf16 v[36:39], a[244:247], v[68:71], v[20:23]
    v_mfma_f32_16x16x32_bf16 v[24:27], a[216:219], v[60:63], v[24:27]
    v_mfma_f32_16x16x32_bf16 v[24:27], a[232:235], v[64:67], v[24:27]
    buffer_store_dwordx4 v[184:187], v5, s[20:23], s63 offen sc1
    v_mfma_f32_16x16x32_bf16 v[40:43], a[248:251], v[68:71], v[24:27]
    v_mfma_f32_16x16x32_bf16 v[28:31], a[220:223], v[60:63], v[28:31]
    v_mfma_f32_16x16x32_bf16 v[28:31], a[236:239], v[64:67], v[28:31]
    s_waitcnt lgkmcnt(0)
    v_mfma_f32_16x16x32_bf16 v[44:47], a[252:255], v[68:71], v[28:31]
    s_branch KP_loop1
PG_6_prev_end:
    .p2align 12
PG_6:
    s_setpc_b64 s[82:83]
PG_6_go:

    s_mov_b32 s31, 1
    s_waitcnt vmcnt(14)
KP_loop2:

    s_waitcnt lgkmcnt(4)
    v_mfma_f32_16x16x32_bf16 v[80:83], a[0:3], v[152:155], v[80:83]
    ds_read_b128 a[32:35], v5 offset:8192
    v_mfma_f32_16x16x32_bf16 v[80:83], a[4:7], v[160:163], v[80:83]
    ds_read_b128 a[36:39], v5 offset:9216
    v_mfma_f32_16x16x32_bf16 v[80:83], a[8:11], v[168:171], v[80:83]
    ds_read_b128 a[40:43], v5 offset:10240
    v_mfma_f32_16x16x32_bf16 v[80:83], a[12:15], v[176:179], v[80:83]
    ds_read_b128 a[44:47], v5 offset:11264
    v_mfma_f32_16x16x32_bf16 v[84:87], a[0:3], v[156:159], v[84:87]
    buffer_load_dwordx4 v[224:227], v5, s[44:47], s74 offen offset:0 sc1
    v_mfma_f32_16x16x32_bf16 v[84:87], a[4:7], v[164:167], v[84:87]
    v_mfma_f32_16x16x32_bf16 v[84:87], a[8:11], v[172:175], v[84:87]
    v_mfma_f32_16x16x32_bf16 v[84:87], a[12:15], v[180:183], v[84:87]
    buffer_load_dwordx4 v5, s[24:27], s60 offen offset:2048 sc1 lds
    s_waitcnt lgkmcnt(4)
    v_mfma_f32_16x16x32_bf16 v[88:91], a[16:19], v[152:155], v[88:91]
    ds_read_b128 a[0:3], v5 offset:12288
    v_mfma_f32_16x16x32_bf16 v[88:91], a[20:23], v[160:163], v[88:91]
    ds_read_b128 a[4:7], v5 offset:13312
    v_mfma_f32_16x16x32_bf16 v[88:91], a[24:27], v[168:171], v[88:91]
    ds_read_b128 a[8:11], v5 offset:14336
    v_mfma_f32_16x16x32_bf16 v[88:91], a[28:31], v[176:179], v[88:91]
    ds_read_b128 a[12:15], v5 offset:15360
    v_mfma_f32_16x16x32_bf16 v[92:95], a[16:19], v[156:159], v[92:95]
    buffer_load_dwordx4 v[228:231], v5, s[44:47], s74 offen offset:1024 sc1
    v_mfma_f32_16x16x32_bf16 v[92:95], a[20:23], v[164:167], v[92:95]
    s_add_u32 s74, s74, 131072
    v_mfma_f32_16x16x32_bf16 v[92:95], a[24:27], v[172:175], v[92:95]
    v_mfma_f32_16x16x32_bf16 v[92:95], a[28:31], v[180:183], v[92:95]
    buffer_load_dwordx4 v5, s[24:27], s60 offen offset:3072 sc1 lds
    s_add_u32 s60, s60, 4096
    s_waitcnt lgkmcnt(4)
    v_mfma_f32_16x16x32_bf16 v[96:99], a[32:35], v[152:155], v[96:99]
    ds_read_b128 a[16:19], v5 offset:16384
    v_mfma_f32_16x16x32_bf16 v[96:99], a[36:39], v[160:163], v[96:99]
    ds_read_b128 a[20:23], v5 offset:17408
    v_mfma_f32_16x16x32_bf16 v[96:99], a[40:43], v[168:171], v[96:99]
    ds_read_b128 a[24:27], v5 offset:18432
    v_mfma_f32_16x16x32_bf16 v[96:99], a[44:47], v[176:179], v[96:99]
    ds_read_b128 a[28:31], v5 offset:19456
    v_mfma_f32_16x16x32_bf16 v[100:103], a[32:35], v[156:159], v[100:103]
    buffer_load_dwordx4 v[232:235], v5, s[44:47], s74 offen offset:0 sc1
    v_mfma_f32_16x16x32_bf16 v[100:103], a[36:39], v[164:167], v[100:103]
    s_add_u32 m0, s59, 77824
    v_mfma_f32_16x16x32_bf16 v[100:103], a[40:43], v[172:175], v[100:103]
    v_mfma_f32_16x16x32_bf16 v[100:103], a[44:47], v[180:183], v[100:103]
    buffer_load_dwordx4 v5, s[24:27], s60 offen offset:0 sc1 lds
    s_waitcnt lgkmcnt(4)
    v_mfma_f32_16x16x32_bf16 v[104:107], a[0:3], v[152:155], v[104:107]
    ds_read_b128 a[32:35], v5 offset:20480
    v_mfma_f32_16x16x32_bf16 v[104:107], a[4:7], v[160:163], v[104:107]
    ds_read_b128 a[36:39], v5 offset:21504
    v_mfma_f32_16x16x32_bf16 v[104:107], a[8:11], v[168:171], v[104:107]
    ds_read_b128 a[40:43], v5 offset:22528
    v_mfma_f32_16x16x32_bf16 v[104:107], a[12:15], v[176:179], v[104:107]
    ds_read_b128 a[44:47], v5 offset:23552
    v_mfma_f32_16x16x32_bf16 v[108:111], a[0:3], v[156:159], v[108:111]
    buffer_load_dwordx4 v[236:239], v5, s[44:47], s74 offen offset:1024 sc1
    v_mfma_f32_16x16x32_bf16 v[108:111], a[4:7], v[164:167], v[108:111]
    s_add_u32 s74, s74, 131072
    v_mfma_f32_16x16x32_bf16 v[108:111], a[8:11], v[172:175], v[108:111]
    v_mfma_f32_16x16x32_bf16 v[108:111], a[12:15], v[180:183], v[108:111]
    buffer_load_dwordx4 v5, s[24:27], s60 offen offset:1024 sc1 lds
    s_waitcnt lgkmcnt(4)
    v_mfma_f32_16x16x32_bf16 v[112:115], a[16:19], v[152:155], v[112:115]
    ds_read_b128 a[0:3], v5 offset:24576
    v_mfma_f32_16x16x32_bf16 v[112:115], a[20:23], v[160:163], v[112:115]
    ds_read_b128 a[4:7], v5 offset:25600
    v_mfma_f32_16x16x32_bf16 v[112:115], a[24:27], v[168:171], v[112:115]
    ds_read_b128 a[8:11], v5 offset:26624
    v_mfma_f32_16x16x32_bf16 v[112:115], a[28:31], v[176:179], v[112:115]
    ds_read_b128 a[12:15], v5 offset:27648
    v_mfma_f32_16x16x32_bf16 v[116:119], a[16:19], v[156:159], v[116:119]
    buffer_load_dwordx4 v[240:243], v5, s[44:47], s74 offen offset:0 sc1
    v_mfma_f32_16x16x32_bf16 v[116:119], a[20:23], v[164:167], v[116:119]
    v_mfma_f32_16x16x32_bf16 v[116:119], a[24:27], v[172:175], v[116:119]
    v_mfma_f32_16x16x32_bf16 v[116:119], a[28:31], v[180:183], v[116:119]
    buffer_load_dwordx4 v5, s[24:27], s60 offen offset:2048 sc1 lds
    s_waitcnt lgkmcnt(4)
    v_mfma_f32_16x16x32_bf16 v[120:123], a[32:35], v[152:155], v[120:123]
    ds_read_b128 a[16:19], v5 offset:28672
    v_mfma_f32_16x16x32_bf16 v[120:123], a[36:39], v[160:163], v[120:123]
    ds_read_b128 a[20:23], v5 offset:29696
    v_mfma_f32_16x16x32_bf16 v[120:123], a[40:43], v[168:171], v[120:123]
    ds_read_b128 a[24:27], v5 offset:30720
    v_mfma_f32_16x16x32_bf16 v[120:123], a[44:47], v[176:179], v[120:123]
    ds_read_b128 a[28:31], v5 offset:31744
    v_mfma_f32_16x16x32_bf16 v[124:127], a[32:35], v[156:159], v[124:127]
    buffer_load_dwordx4 v[244:247], v5, s[44:47], s74 offen offset:1024 sc1
    v_mfma_f32_16x16x32_bf16 v[124:127], a[36:39], v[164:167], v[124:127]
    s_add_u32 s74, s74, 131072
    v_mfma_f32_16x16x32_bf16 v[124:127], a[40:43], v[172:175], v[124:127]
    v_mfma_f32_16x16x32_bf16 v[124:127], a[44:47], v[180:183], v[124:127]
    buffer_load_dwordx4 v5, s[24:27], s60 offen offset:3072 sc1 lds
    s_add_u32 s60, s60, 4096
    s_waitcnt lgkmcnt(4)
    v_mfma_f32_16x16x32_bf16 v[128:131], a[0:3], v[152:155], v[128:131]
    ds_read_b128 a[32:35], v5 offset:32768
    v_mfma_f32_16x16x32_bf16 v[128:131], a[4:7], v[160:163], v[128:131]
    ds_read_b128 a[36:39], v5 offset:33792
    buffer_load_dwordx4 v[248:251], v5, s[44:47], s74 offen offset:0 sc1
    v_mfma_f32_16x16x32_bf16 v[128:131], a[8:11], v[168:171], v[128:131]
    ds_read_b128 a[40:43], v5 offset:34816
    v_mfma_f32_16x16x32_bf16 v[128:131], a[12:15], v[176:179], v[128:131]
    ds_read_b128 a[44:47], v5 offset:35840
    v_mfma_f32_16x16x32_bf16 v[132:135], a[0:3], v[156:159], v[132:135]
    s_add_u32 m0, s59, 81920
    v_mfma_f32_16x16x32_bf16 v[132:135], a[4:7], v[164:167], v[132:135]
    buffer_load_dwordx4 v5, s[24:27], s60 offen offset:0 sc1 lds
    v_mfma_f32_16x16x32_bf16 v[132:135], a[8:11], v[172:175], v[132:135]
    v_mfma_f32_16x16x32_bf16 v[132:135], a[12:15], v[180:183], v[132:135]
    s_waitcnt vmcnt(14) lgkmcnt(0)
    s_barrier
    v_mfma_f32_16x16x32_bf16 v[136:139], a[16:19], v[152:155], v[136:139]
    ds_read_b128 a[0:3], v3 offset:0
    s_add_u32 s60, s60, 28672
    s_cmp_eq_u32 s60, s73
    v_mfma_f32_16x16x32_bf16 v[136:139], a[20:23], v[160:163], v[136:139]
    ds_read_b128 a[4:7], v3 offset:1024
    s_cselect_b32 s60, s72, s60
    v_mfma_f32_16x16x32_bf16 v[136:139], a[24:27], v[168:171], v[136:139]
    ds_read_b128 a[8:11], v3 offset:2048
    buffer_store_dword v77, v11, s[52:55], 0 offen sc1
    v_mfma_f32_16x16x32_bf16 v[136:139], a[28:31], v[176:179], v[136:139]
    ds_read_b128 a[12:15], v3 offset:3072
    v_mfma_f32_16x16x32_bf16 v[140:143], a[16:19], v[156:159], v[140:143]
    s_mov_b32 s54, 0
    v_mfma_f32_16x16x32_bf16 v[140:143], a[20:23], v[164:167], v[140:143]
    buffer_load_dwordx4 v[252:255], v5, s[44:47], s74 offen offset:1024 sc1
    v_mfma_f32_16x16x32_bf16 v[140:143], a[24:27], v[172:175], v[140:143]
    s_add_u32 m0, s59, 0
    v_mfma_f32_16x16x32_bf16 v[140:143], a[28:31], v[180:183], v[140:143]
    buffer_load_dwordx4 v5, s[24:27], s60 offen offset:0 sc1 lds
    v_mfma_f32_16x16x32_bf16 v[144:147], a[32:35], v[152:155], v[144:147]
    ds_read_b128 a[16:19], v3 offset:4096
    v_mfma_f32_16x16x32_bf16 v[144:147], a[36:39], v[160:163], v[144:147]
    ds_read_b128 a[20:23], v3 offset:5120
    v_mfma_f32_16x16x32_bf16 v[144:147], a[40:43], v[168:171], v[144:147]
    ds_read_b128 a[24:27], v3 offset:6144
    v_mfma_f32_16x16x32_bf16 v[144:147], a[44:47], v[176:179], v[144:147]
    ds_read_b128 a[28:31], v3 offset:7168
    v_mfma_f32_16x16x32_bf16 v[148:151], a[32:35], v[156:159], v[148:151]
    buffer_load_dwordx4 v5, s[24:27], s60 offen offset:1024 sc1 lds
    s_add_u32 s74, s74, 655360
    v_mfma_f32_16x16x32_bf16 v[148:151], a[36:39], v[164:167], v[148:151]
    s_cmp_ge_u32 s74, s75
    v_mfma_f32_16x16x32_bf16 v[148:151], a[40:43], v[172:175], v[148:151]
    s_cselect_b32 s30, 4718592, 0
    v_mfma_f32_16x16x32_bf16 v[148:151], a[44:47], v[180:183], v[148:151]
    s_sub_u32 s74, s74, s30

    s_waitcnt lgkmcnt(4)
    v_mfma_f32_16x16x32_bf16 v[80:83], a[0:3], v[184:187], v[80:83]
    ds_read_b128 a[32:35], v3 offset:8192
    v_mfma_f32_16x16x32_bf16 v[80:83], a[4:7], v[192:195], v[80:83]
    ds_read_b128 a[36:39], v3 offset:9216
    v_mfma_f32_16x16x32_bf16 v[80:83], a[8:11], v[200:203], v[80:83]
    ds_read_b128 a[40:43], v3 offset:10240
    v_mfma_f32_16x16x32_bf16 v[80:83], a[12:15], v[208:211], v[80:83]
    ds_read_b128 a[44:47], v3 offset:11264
    v_mfma_f32_16x16x32_bf16 v[84:87], a[0:3], v[188:191], v[84:87]
    buffer_load_dwordx4 v[152:155], v5, s[44:47], s74 offen offset:0 sc1
    v_mfma_f32_16x16x32_bf16 v[84:87], a[4:7], v[196:199], v[84:87]
    v_mfma_f32_16x16x32_bf16 v[84:87], a[8:11], v[204:207], v[84:87]
    v_mfma_f32_16x16x32_bf16 v[84:87], a[12:15], v[212:215], v[84:87]
    buffer_load_dwordx4 v5, s[24:27], s60 offen offset:2048 sc1 lds
    s_waitcnt lgkmcnt(4)
    v_mfma_f32_16x16x32_bf16 v[88:91], a[16:19], v[184:187], v[88:91]
    ds_read_b128 a[0:3], v3 offset:12288
    v_mfma_f32_16x16x32_bf16 v[88:91], a[20:23], v[192:195], v[88:91]
    ds_read_b128 a[4:7], v3 offset:13312
    v_mfma_f32_16x16x32_bf16 v[88:91], a[24:27], v[200:203], v[88:91]
    ds_read_b128 a[8:11], v3 offset:14336
    v_mfma_f32_16x16x32_bf16 v[88:91], a[28:31], v[208:211], v[88:91]
    ds_read_b128 a[12:15], v3 offset:15360
    v_mfma_f32_16x16x32_bf16 v[92:95], a[16:19], v[188:191], v[92:95]
    buffer_load_dwordx4 v[156:159], v5, s[44:47], s74 offen offset:1024 sc1
    v_mfma_f32_16x16x32_bf16 v[92:95], a[20:23], v[196:199], v[92:95]
    s_add_u32 s74, s74, 131072
    v_mfma_f32_16x16x32_bf16 v[92:95], a[24:27], v[204:207], v[92:95]
    v_mfma_f32_16x16x32_bf16 v[92:95], a[28:31], v[212:215], v[92:95]
    buffer_load_dwordx4 v5, s[24:27], s60 offen offset:3072 sc1 lds
    s_add_u32 s60, s60, 4096
    s_waitcnt lgkmcnt(4)
    v_mfma_f32_16x16x32_bf16 v[96:99], a[32:35], v[184:187], v[96:99]
    ds_read_b128 a[16:19], v3 offset:16384
    v_mfma_f32_16x16x32_bf16 v[96:99], a[36:39], v[192:195], v[96:99]
    ds_read_b128 a[20:23], v3 offset:17408
    v_mfma_f32_16x16x32_bf16 v[96:99], a[40:43], v[200:203], v[96:99]
    ds_read_b128 a[24:27], v3 offset:18432
    v_mfma_f32_16x16x32_bf16 v[96:99], a[44:47], v[208:211], v[96:99]
    ds_read_b128 a[28:31], v3 offset:19456
    v_mfma_f32_16x16x32_bf16 v[100:103], a[32:35], v[188:191], v[100:103]
    buffer_load_dwordx4 v[160:163], v5, s[44:47], s74 offen offset:0 sc1
    v_mfma_f32_16x16x32_bf16 v[100:103], a[36:39], v[196:199], v[100:103]
    s_add_u32 m0, s59, 4096
    v_mfma_f32_16x16x32_bf16 v[100:103], a[40:43], v[204:207], v[100:103]
    v_mfma_f32_16x16x32_bf16 v[100:103], a[44:47], v[212:215], v[100:103]
    buffer_load_dwordx4 v5, s[24:27], s60 offen offset:0 sc1 lds
    s_waitcnt lgkmcnt(4)
    v_mfma_f32_16x16x32_bf16 v[104:107], a[0:3], v[184:187], v[104:107]
    ds_read_b128 a[32:35], v3 offset:20480
    v_mfma_f32_16x16x32_bf16 v[104:107], a[4:7], v[192:195], v[104:107]
    ds_read_b128 a[36:39], v3 offset:21504
    v_mfma_f32_16x16x32_bf16 v[104:107], a[8:11], v[200:203], v[104:107]
    ds_read_b128 a[40:43], v3 offset:22528
    v_mfma_f32_16x16x32_bf16 v[104:107], a[12:15], v[208:211], v[104:107]
    ds_read_b128 a[44:47], v3 offset:23552
    v_mfma_f32_16x16x32_bf16 v[108:111], a[0:3], v[188:191], v[108:111]
    buffer_load_dwordx4 v[164:167], v5, s[44:47], s74 offen offset:1024 sc1
    v_mfma_f32_16x16x32_bf16 v[108:111], a[4:7], v[196:199], v[108:111]
    s_add_u32 s74, s74, 131072
    v_mfma_f32_16x16x32_bf16 v[108:111], a[8:11], v[204:207], v[108:111]
    v_mfma_f32_16x16x32_bf16 v[108:111], a[12:15], v[212:215], v[108:111]
    buffer_load_dwordx4 v5, s[24:27], s60 offen offset:1024 sc1 lds
    s_waitcnt lgkmcnt(4)
    v_mfma_f32_16x16x32_bf16 v[112:115], a[16:19], v[184:187], v[112:115]
    ds_read_b128 a[0:3], v3 offset:24576
    v_mfma_f32_16x16x32_bf16 v[112:115], a[20:23], v[192:195], v[112:115]
    ds_read_b128 a[4:7], v3 offset:25600
    buffer_load_dword v76, v13, s[48:51], 0 offen sc1
    v_mfma_f32_16x16x32_bf16 v[112:115], a[24:27], v[200:203], v[112:115]
    ds_read_b128 a[8:11], v3 offset:26624
    v_mfma_f32_16x16x32_bf16 v[112:115], a[28:31], v[208:211], v[112:115]
    ds_read_b128 a[12:15], v3 offset:27648
    v_mfma_f32_16x16x32_bf16 v[116:119], a[16:19], v[188:191], v[116:119]
    buffer_load_dwordx4 v[168:171], v5, s[44:47], s74 offen offset:0 sc1
    v_mfma_f32_16x16x32_bf16 v[116:119], a[20:23], v[196:199], v[116:119]
    v_mfma_f32_16x16x32_bf16 v[116:119], a[24:27], v[204:207], v[116:119]
    v_mfma_f32_16x16x32_bf16 v[116:119], a[28:31], v[212:215], v[116:119]
    buffer_load_dwordx4 v5, s[24:27], s60 offen offset:2048 sc1 lds
    s_waitcnt lgkmcnt(4)
    v_mfma_f32_16x16x32_bf16 v[120:123], a[32:35], v[184:187], v[120:123]
    ds_read_b128 a[16:19], v3 offset:28672
    v_mfma_f32_16x16x32_bf16 v[120:123], a[36:39], v[192:195], v[120:123]
    ds_read_b128 a[20:23], v3 offset:29696
    v_mfma_f32_16x16x32_bf16 v[120:123], a[40:43], v[200:203], v[120:123]
    ds_read_b128 a[24:27], v3 offset:30720
    v_mfma_f32_16x16x32_bf16 v[120:123], a[44:47], v[208:211], v[120:123]
    ds_read_b128 a[28:31], v3 offset:31744
    v_mfma_f32_16x16x32_bf16 v[124:127], a[32:35], v[188:191], v[124:127]
    buffer_load_dwordx4 v[172:175], v5, s[44:47], s74 offen offset:1024 sc1
    v_mfma_f32_16x16x32_bf16 v[124:127], a[36:39], v[196:199], v[124:127]
    s_add_u32 s74, s74, 131072
    v_mfma_f32_16x16x32_bf16 v[124:127], a[40:43], v[204:207], v[124:127]
    v_mfma_f32_16x16x32_bf16 v[124:127], a[44:47], v[212:215], v[124:127]
    buffer_load_dwordx4 v5, s[24:27], s60 offen offset:3072 sc1 lds
    s_add_u32 s60, s60, 4096
    s_waitcnt lgkmcnt(4)
    v_mfma_f32_16x16x32_bf16 v[128:131], a[0:3], v[184:187], v[128:131]
    ds_read_b128 a[32:35], v3 offset:32768
    v_mfma_f32_16x16x32_bf16 v[128:131], a[4:7], v[192:195], v[128:131]
    ds_read_b128 a[36:39], v3 offset:33792
    buffer_load_dwordx4 v[176:179], v5, s[44:47], s74 offen offset:0 sc1
    v_mfma_f32_16x16x32_bf16 v[128:131], a[8:11], v[200:203], v[128:131]
    ds_read_b128 a[40:43], v3 offset:34816
    v_mfma_f32_16x16x32_bf16 v[128:131], a[12:15], v[208:211], v[128:131]
    ds_read_b128 a[44:47], v3 offset:35840
    v_mfma_f32_16x16x32_bf16 v[132:135], a[0:3], v[188:191], v[132:135]
    s_add_u32 m0, s59, 8192
    v_mfma_f32_16x16x32_bf16 v[132:135], a[4:7], v[196:199], v[132:135]
    buffer_load_dwordx4 v5, s[24:27], s60 offen offset:0 sc1 lds
    v_mfma_f32_16x16x32_bf16 v[132:135], a[8:11], v[204:207], v[132:135]
    v_mfma_f32_16x16x32_bf16 v[132:135], a[12:15], v[212:215], v[132:135]
    s_waitcnt vmcnt(17) lgkmcnt(0)
    s_barrier
    v_mfma_f32_16x16x32_bf16 v[136:139], a[16:19], v[184:187], v[136:139]
    ds_read_b128 a[0:3], v4 offset:0
    s_add_u32 s60, s60, 28672
    v_mfma_f32_16x16x32_bf16 v[136:139], a[20:23], v[192:195], v[136:139]
    ds_read_b128 a[4:7], v4 offset:1024
    s_cmp_eq_u32 s60, s73
    v_mfma_f32_16x16x32_bf16 v[136:139], a[24:27], v[200:203], v[136:139]
    ds_read_b128 a[8:11], v4 offset:2048
    s_cselect_b32 s60, s72, s60
    v_mfma_f32_16x16x32_bf16 v[136:139], a[28:31], v[208:211], v[136:139]
    ds_read_b128 a[12:15], v4 offset:3072
    buffer_load_dwordx4 v[180:183], v5, s[44:47], s74 offen offset:1024 sc1
    v_mfma_f32_16x16x32_bf16 v[140:143], a[16:19], v[188:191], v[140:143]
    s_add_u32 m0, s59, 36864
    v_mfma_f32_16x16x32_bf16 v[140:143], a[20:23], v[196:199], v[140:143]
    v_mfma_f32_16x16x32_bf16 v[140:143], a[24:27], v[204:207], v[140:143]
    v_mfma_f32_16x16x32_bf16 v[140:143], a[28:31], v[212:215], v[140:143]
    buffer_load_dwordx4 v5, s[24:27], s60 offen offset:0 sc1 lds
    v_mfma_f32_16x16x32_bf16 v[144:147], a[32:35], v[184:187], v[144:147]
    ds_read_b128 a[16:19], v4 offset:4096
    v_mfma_f32_16x16x32_bf16 v[144:147], a[36:39], v[192:195], v[144:147]
    ds_read_b128 a[20:23], v4 offset:5120
    v_mfma_f32_16x16x32_bf16 v[144:147], a[40:43], v[200:203], v[144:147]
    ds_read_b128 a[24:27], v4 offset:6144
    v_mfma_f32_16x16x32_bf16 v[144:147], a[44:47], v[208:211], v[144:147]
    ds_read_b128 a[28:31], v4 offset:7168
    v_mfma_f32_16x16x32_bf16 v[148:151], a[32:35], v[188:191], v[148:151]
    buffer_load_dwordx4 v5, s[24:27], s60 offen offset:1024 sc1 lds
    s_add_u32 s74, s74, 655360
    v_mfma_f32_16x16x32_bf16 v[148:151], a[36:39], v[196:199], v[148:151]
    s_cmp_ge_u32 s74, s75
    v_mfma_f32_16x16x32_bf16 v[148:151], a[40:43], v[204:207], v[148:151]
    s_cselect_b32 s30, 4718592, 0
    v_mfma_f32_16x16x32_bf16 v[148:151], a[44:47], v[212:215], v[148:151]
    s_sub_u32 s74, s74, s30

    s_waitcnt lgkmcnt(4)
    s_waitcnt vmcnt(9)
    v_cmp_lt_i32 vcc, v76, v14
    s_mov_b32 s50, 0
    s_cbranch_vccnz KP_p1s
KP_p1ok:
    v_mov_b32 v14, 0
    v_mfma_f32_16x16x32_bf16 v[80:83], a[0:3], v[224:227], v[80:83]
    ds_read_b128 a[32:35], v4 offset:8192
    v_mfma_f32_16x16x32_bf16 v[80:83], a[4:7], v[232:235], v[80:83]
    ds_read_b128 a[36:39], v4 offset:9216
    v_mfma_f32_16x16x32_bf16 v[80:83], a[8:11], v[240:243], v[80:83]
    ds_read_b128 a[40:43], v4 offset:10240
    v_mfma_f32_16x16x32_bf16 v[80:83], a[12:15], v[248:251], v[80:83]
    ds_read_b128 a[44:47], v4 offset:11264
    v_mfma_f32_16x16x32_bf16 v[84:87], a[0:3], v[228:231], v[84:87]
    buffer_load_dwordx4 v[184:187], v5, s[44:47], s74 offen offset:0 sc1
    v_mfma_f32_16x16x32_bf16 v[84:87], a[4:7], v[236:239], v[84:87]
    v_mfma_f32_16x16x32_bf16 v[84:87], a[8:11], v[244:247], v[84:87]
    v_mfma_f32_16x16x32_bf16 v[84:87], a[12:15], v[252:255], v[84:87]
    buffer_load_dwordx4 v5, s[24:27], s60 offen offset:2048 sc1 lds
    s_waitcnt lgkmcnt(4)
    v_mfma_f32_16x16x32_bf16 v[88:91], a[16:19], v[224:227], v[88:91]
    ds_read_b128 a[0:3], v4 offset:12288
    v_mfma_f32_16x16x32_bf16 v[88:91], a[20:23], v[232:235], v[88:91]
    ds_read_b128 a[4:7], v4 offset:13312
    v_mfma_f32_16x16x32_bf16 v[88:91], a[24:27], v[240:243], v[88:91]
    ds_read_b128 a[8:11], v4 offset:14336
    v_mfma_f32_16x16x32_bf16 v[88:91], a[28:31], v[248:251], v[88:91]
    ds_read_b128 a[12:15], v4 offset:15360
    v_mfma_f32_16x16x32_bf16 v[92:95], a[16:19], v[228:231], v[92:95]
    buffer_load_dwordx4 v[188:191], v5, s[44:47], s74 offen offset:1024 sc1
    v_mfma_f32_16x16x32_bf16 v[92:95], a[20:23], v[236:239], v[92:95]
    s_add_u32 s74, s74, 131072
    v_mfma_f32_16x16x32_bf16 v[92:95], a[24:27], v[244:247], v[92:95]
    v_mfma_f32_16x16x32_bf16 v[92:95], a[28:31], v[252:255], v[92:95]
    buffer_load_dwordx4 v5, s[24:27], s60 offen offset:3072 sc1 lds
    s_add_u32 s60, s60, 4096
    s_waitcnt lgkmcnt(4)
    v_mfma_f32_16x16x32_bf16 v[96:99], a[32:35], v[224:227], v[96:99]
    ds_read_b128 a[16:19], v4 offset:16384
    v_mfma_f32_16x16x32_bf16 v[96:99], a[36:39], v[232:235], v[96:99]
    ds_read_b128 a[20:23], v4 offset:17408
    v_mfma_f32_16x16x32_bf16 v[96:99], a[40:43], v[240:243], v[96:99]
    ds_read_b128 a[24:27], v4 offset:18432
    v_mfma_f32_16x16x32_bf16 v[96:99], a[44:47], v[248:251], v[96:99]
    ds_read_b128 a[28:31], v4 offset:19456
    v_mfma_f32_16x16x32_bf16 v[100:103], a[32:35], v[228:231], v[100:103]
    buffer_load_dwordx4 v[192:195], v5, s[44:47], s74 offen offset:0 sc1
    v_mfma_f32_16x16x32_bf16 v[100:103], a[36:39], v[236:239], v[100:103]
    s_add_u32 m0, s59, 40960
    v_mfma_f32_16x16x32_bf16 v[100:103], a[40:43], v[244:247], v[100:103]
    v_mfma_f32_16x16x32_bf16 v[100:103], a[44:47], v[252:255], v[100:103]
    buffer_load_dwordx4 v5, s[24:27], s60 offen offset:0 sc1 lds
    s_waitcnt lgkmcnt(4)
    v_mfma_f32_16x16x32_bf16 v[104:107], a[0:3], v[224:227], v[104:107]
    ds_read_b128 a[32:35], v4 offset:20480
    v_mfma_f32_16x16x32_bf16 v[104:107], a[4:7], v[232:235], v[104:107]
    ds_read_b128 a[36:39], v4 offset:21504
    v_mfma_f32_16x16x32_bf16 v[104:107], a[8:11], v[240:243], v[104:107]
    ds_read_b128 a[40:43], v4 offset:22528
    v_mfma_f32_16x16x32_bf16 v[104:107], a[12:15], v[248:251], v[104:107]
    ds_read_b128 a[44:47], v4 offset:23552
    v_mfma_f32_16x16x32_bf16 v[108:111], a[0:3], v[228:231], v[108:111]
    buffer_load_dwordx4 v[196:199], v5, s[44:47], s74 offen offset:1024 sc1
    v_mfma_f32_16x16x32_bf16 v[108:111], a[4:7], v[236:239], v[108:111]
    s_add_u32 s74, s74, 131072
    v_mfma_f32_16x16x32_bf16 v[108:111], a[8:11], v[244:247], v[108:111]
    v_mfma_f32_16x16x32_bf16 v[108:111], a[12:15], v[252:255], v[108:111]
    buffer_load_dwordx4 v5, s[24:27], s60 offen offset:1024 sc1 lds
    s_waitcnt lgkmcnt(4)
    v_mfma_f32_16x16x32_bf16 v[112:115], a[16:19], v[224:227], v[112:115]
    ds_read_b128 a[0:3], v4 offset:24576
    v_mfma_f32_16x16x32_bf16 v[112:115], a[20:23], v[232:235], v[112:115]
    ds_read_b128 a[4:7], v4 offset:25600
    v_mfma_f32_16x16x32_bf16 v[112:115], a[24:27], v[240:243], v[112:115]
    ds_read_b128 a[8:11], v4 offset:26624
    v_mfma_f32_16x16x32_bf16 v[112:115], a[28:31], v[248:251], v[112:115]
    ds_read_b128 a[12:15], v4 offset:27648
    v_mfma_f32_16x16x32_bf16 v[116:119], a[16:19], v[228:231], v[116:119]
    buffer_load_dwordx4 v[200:203], v5, s[44:47], s74 offen offset:0 sc1
    v_mfma_f32_16x16x32_bf16 v[116:119], a[20:23], v[236:239], v[116:119]
    v_mfma_f32_16x16x32_bf16 v[116:119], a[24:27], v[244:247], v[116:119]
    v_mfma_f32_16x16x32_bf16 v[116:119], a[28:31], v[252:255], v[116:119]
    buffer_load_dwordx4 v5, s[24:27], s60 offen offset:2048 sc1 lds
    s_waitcnt lgkmcnt(4)
    v_mfma_f32_16x16x32_bf16 v[120:123], a[32:35], v[224:227], v[120:123]
    ds_read_b128 a[16:19], v4 offset:28672
    v_mfma_f32_16x16x32_bf16 v[120:123], a[36:39], v[232:235], v[120:123]
    ds_read_b128 a[20:23], v4 offset:29696
    v_mfma_f32_16x16x32_bf16 v[120:123], a[40:43], v[240:243], v[120:123]
    ds_read_b128 a[24:27], v4 offset:30720
    v_mfma_f32_16x16x32_bf16 v[120:123], a[44:47], v[248:251], v[120:123]
    ds_read_b128 a[28:31], v4 offset:31744
    v_mfma_f32_16x16x32_bf16 v[124:127], a[32:35], v[228:231], v[124:127]
    buffer_load_dwordx4 v[204:207], v5, s[44:47], s74 offen offset:1024 sc1
    v_mfma_f32_16x16x32_bf16 v[124:127], a[36:39], v[236:239], v[124:127]
    s_add_u32 s74, s74, 131072
    v_mfma_f32_16x16x32_bf16 v[124:127], a[40:43], v[244:247], v[124:127]
    v_mfma_f32_16x16x32_bf16 v[124:127], a[44:47], v[252:255], v[124:127]
    buffer_load_dwordx4 v5, s[24:27], s60 offen offset:3072 sc1 lds
    s_add_u32 s60, s60, 4096
    s_waitcnt lgkmcnt(4)
    v_mfma_f32_16x16x32_bf16 v[128:131], a[0:3], v[224:227], v[128:131]
    ds_read_b128 a[32:35], v4 offset:32768
    v_mfma_f32_16x16x32_bf16 v[128:131], a[4:7], v[232:235], v[128:131]
    ds_read_b128 a[36:39], v4 offset:33792
    buffer_load_dwordx4 v[208:211], v5, s[44:47], s74 offen offset:0 sc1
    v_mfma_f32_16x16x32_bf16 v[128:131], a[8:11], v[240:243], v[128:131]
    ds_read_b128 a[40:43], v4 offset:34816
    v_mfma_f32_16x16x32_bf16 v[128:131], a[12:15], v[248:251], v[128:131]
    ds_read_b128 a[44:47], v4 offset:35840
    v_mfma_f32_16x16x32_bf16 v[132:135], a[0:3], v[228:231], v[132:135]
    s_add_u32 m0, s59, 45056
    v_mfma_f32_16x16x32_bf16 v[132:135], a[4:7], v[236:239], v[132:135]
    buffer_load_dwordx4 v5, s[24:27], s60 offen offset:0 sc1 lds
    v_mfma_f32_16x16x32_bf16 v[132:135], a[8:11], v[244:247], v[132:135]
    v_mfma_f32_16x16x32_bf16 v[132:135], a[12:15], v[252:255], v[132:135]
    s_waitcnt vmcnt(16) lgkmcnt(0)
    s_barrier
    v_mfma_f32_16x16x32_bf16 v[136:139], a[16:19], v[224:227], v[136:139]
    ds_read_b128 a[0:3], v5 offset:0
    s_add_u32 s60, s60, 28672
    v_mfma_f32_16x16x32_bf16 v[136:139], a[20:23], v[232:235], v[136:139]
    ds_read_b128 a[4:7], v5 offset:1024
    s_cmp_eq_u32 s60, s73
    v_mfma_f32_16x16x32_bf16 v[136:139], a[24:27], v[240:243], v[136:139]
    ds_read_b128 a[8:11], v5 offset:2048
    s_cselect_b32 s60, s72, s60
    v_mfma_f32_16x16x32_bf16 v[136:139], a[28:31], v[248:251], v[136:139]
    ds_read_b128 a[12:15], v5 offset:3072
    buffer_load_dwordx4 v[212:215], v5, s[44:47], s74 offen offset:1024 sc1
    v_mfma_f32_16x16x32_bf16 v[140:143], a[16:19], v[228:231], v[140:143]
    s_add_u32 m0, s59, 73728
    v_mfma_f32_16x16x32_bf16 v[140:143], a[20:23], v[236:239], v[140:143]
    v_mfma_f32_16x16x32_bf16 v[140:143], a[24:27], v[244:247], v[140:143]
    v_mfma_f32_16x16x32_bf16 v[140:143], a[28:31], v[252:255], v[140:143]
    buffer_load_dwordx4 v5, s[24:27], s60 offen offset:0 sc1 lds
    v_mfma_f32_16x16x32_bf16 v[144:147], a[32:35], v[224:227], v[144:147]
    ds_read_b128 a[16:19], v5 offset:4096
    v_mfma_f32_16x16x32_bf16 v[144:147], a[36:39], v[232:235], v[144:147]
    ds_read_b128 a[20:23], v5 offset:5120
    v_mfma_f32_16x16x32_bf16 v[144:147], a[40:43], v[240:243], v[144:147]
    ds_read_b128 a[24:27], v5 offset:6144
    v_mfma_f32_16x16x32_bf16 v[144:147], a[44:47], v[248:251], v[144:147]
    ds_read_b128 a[28:31], v5 offset:7168
    v_mfma_f32_16x16x32_bf16 v[148:151], a[32:35], v[228:231], v[148:151]
    buffer_load_dwordx4 v5, s[24:27], s60 offen offset:1024 sc1 lds
    s_add_u32 s74, s74, 655360
    v_mfma_f32_16x16x32_bf16 v[148:151], a[36:39], v[236:239], v[148:151]
    s_cmp_ge_u32 s74, s75
    s_cselect_b32 s30, 4718592, 0
    v_mfma_f32_16x16x32_bf16 v[148:151], a[40:43], v[244:247], v[148:151]
    s_sub_u32 s74, s74, s30
    v_mfma_f32_16x16x32_bf16 v[148:151], a[44:47], v[252:255], v[148:151]
    s_sub_u32 s31, s31, 1
    s_cbranch_scc0 KP_loop2
    s_branch PG_7_go

KP_d0s:
    s_mov_b32 s61, 1048576
KP_d0:
    s_sleep 2
KP_d0_f:
    buffer_load_dword v76, v13, s[20:23], 0 offen sc1
    s_sub_u32 s61, s61, 1
    s_cbranch_scc1 KP_d0_x
    s_waitcnt vmcnt(0)
    v_cmp_ne_u32 vcc, 1, v76
    s_cbranch_vccnz KP_d0
KP_d0_x:
    s_branch KP_d0ok
KP_p0s:
    s_mov_b32 s61, 1048576
KP_p0:
    s_sleep 2
KP_p0_f:
    buffer_load_dword v76, v13, s[20:23], 0 offen sc1
    s_sub_u32 s61, s61, 1
    s_cbranch_scc1 KP_p0_x
    s_waitcnt vmcnt(0)
    v_cmp_lt_i32 vcc, v76, v15
    s_cbranch_vccnz KP_p0
KP_p0_x:
    s_branch KP_p0ok
KP_p1s:
    s_mov_b32 s61, 1048576
KP_p1:
    s_sleep 2
KP_p1_f:
    buffer_load_dword v76, v13, s[20:23], 0 offen sc1
    s_sub_u32 s61, s61, 1
    s_cbranch_scc1 KP_p1_x
    s_waitcnt vmcnt(0)
    v_cmp_lt_i32 vcc, v76, v14
    s_cbranch_vccnz KP_p1
KP_p1_x:
    s_branch KP_p1ok
PG_7_prev_end:
    .p2align 12
PG_7:
    s_setpc_b64 s[82:83]
PG_7_go:

    s_waitcnt lgkmcnt(4)
    v_mfma_f32_16x16x32_bf16 v[80:83], a[0:3], v[152:155], v[80:83]
    ds_read_b128 a[32:35], v5 offset:8192
    v_mov_b32 v77, 33
    v_mfma_f32_16x16x32_bf16 v[80:83], a[4:7], v[160:163], v[80:83]
    ds_read_b128 a[36:39], v5 offset:9216
    buffer_load_dwordx4 v[224:227], v5, s[44:47], s74 offen offset:0 sc1
    v_mfma_f32_16x16x32_bf16 v[80:83], a[8:11], v[168:171], v[80:83]
    ds_read_b128 a[40:43], v5 offset:10240
    v_mfma_f32_16x16x32_bf16 v[80:83], a[12:15], v[176:179], v[80:83]
    ds_read_b128 a[44:47], v5 offset:11264
    v_mfma_f32_16x16x32_bf16 v[84:87], a[0:3], v[156:159], v[84:87]
    v_mfma_f32_16x16x32_bf16 v[84:87], a[4:7], v[164:167], v[84:87]
    buffer_load_dwordx4 v5, s[24:27], s60 offen offset:2048 sc1 lds
    v_mfma_f32_16x16x32_bf16 v[84:87], a[8:11], v[172:175], v[84:87]
    v_mfma_f32_16x16x32_bf16 v[84:87], a[12:15], v[180:183], v[84:87]
    s_waitcnt lgkmcnt(4)
    v_mfma_f32_16x16x32_bf16 v[88:91], a[16:19], v[152:155], v[88:91]
    ds_read_b128 a[0:3], v5 offset:12288
    v_mfma_f32_16x16x32_bf16 v[88:91], a[20:23], v[160:163], v[88:91]
    ds_read_b128 a[4:7], v5 offset:13312
    buffer_load_dwordx4 v[228:231], v5, s[44:47], s74 offen offset:1024 sc1
    v_mfma_f32_16x16x32_bf16 v[88:91], a[24:27], v[168:171], v[88:91]
    ds_read_b128 a[8:11], v5 offset:14336
    v_mfma_f32_16x16x32_bf16 v[88:91], a[28:31], v[176:179], v[88:91]
    ds_read_b128 a[12:15], v5 offset:15360
    v_mfma_f32_16x16x32_bf16 v[92:95], a[16:19], v[156:159], v[92:95]
    s_add_u32 s74, s74, 131072
    v_mfma_f32_16x16x32_bf16 v[92:95], a[20:23], v[164:167], v[92:95]
    buffer_load_dwordx4 v5, s[24:27], s60 offen offset:3072 sc1 lds
    v_mfma_f32_16x16x32_bf16 v[92:95], a[24:27], v[172:175], v[92:95]
    s_add_u32 s60, s60, 4096
    v_mfma_f32_16x16x32_bf16 v[92:95], a[28:31], v[180:183], v[92:95]
    s_waitcnt lgkmcnt(4)
    v_mfma_f32_16x16x32_bf16 v[96:99], a[32:35], v[152:155], v[96:99]
    ds_read_b128 a[16:19], v5 offset:16384
    v_mfma_f32_16x16x32_bf16 v[96:99], a[36:39], v[160:163], v[96:99]
    ds_read_b128 a[20:23], v5 offset:17408
    buffer_load_dwordx4 v[232:235], v5, s[44:47], s74 offen offset:0 sc1
    v_mfma_f32_16x16x32_bf16 v[96:99], a[40:43], v[168:171], v[96:99]
    ds_read_b128 a[24:27], v5 offset:18432
    v_mfma_f32_16x16x32_bf16 v[96:99], a[44:47], v[176:179], v[96:99]
    ds_read_b128 a[28:31], v5 offset:19456
    v_mfma_f32_16x16x32_bf16 v[100:103], a[32:35], v[156:159], v[100:103]
    s_add_u32 m0, s59, 77824
    v_mfma_f32_16x16x32_bf16 v[100:103], a[36:39], v[164:167], v[100:103]
    buffer_load_dwordx4 v5, s[24:27], s60 offen offset:0 sc1 lds
    v_mfma_f32_16x16x32_bf16 v[100:103], a[40:43], v[172:175], v[100:103]
    v_mfma_f32_16x16x32_bf16 v[100:103], a[44:47], v[180:183], v[100:103]
    s_waitcnt lgkmcnt(4)
    v_mfma_f32_16x16x32_bf16 v[104:107], a[0:3], v[152:155], v[104:107]
    ds_read_b128 a[32:35], v5 offset:20480
    v_mfma_f32_16x16x32_bf16 v[104:107], a[4:7], v[160:163], v[104:107]
    ds_read_b128 a[36:39], v5 offset:21504
    buffer_load_dwordx4 v[236:239], v5, s[44:47], s74 offen offset:1024 sc1
    v_mfma_f32_16x16x32_bf16 v[104:107], a[8:11], v[168:171], v[104:107]
    ds_read_b128 a[40:43], v5 offset:22528
    v_mfma_f32_16x16x32_bf16 v[104:107], a[12:15], v[176:179], v[104:107]
    ds_read_b128 a[44:47], v5 offset:23552
    v_mfma_f32_16x16x32_bf16 v[108:111], a[0:3], v[156:159], v[108:111]
    s_add_u32 s74, s74, 131072
    v_mfma_f32_16x16x32_bf16 v[108:111], a[4:7], v[164:167], v[108:111]
    buffer_load_dwordx4 v5, s[24:27], s60 offen offset:1024 sc1 lds
    v_mfma_f32_16x16x32_bf16 v[108:111], a[8:11], v[172:175], v[108:111]
    v_mfma_f32_16x16x32_bf16 v[108:111], a[12:15], v[180:183], v[108:111]
    s_waitcnt lgkmcnt(4)
    v_mfma_f32_16x16x32_bf16 v[112:115], a[16:19], v[152:155], v[112:115]
    ds_read_b128 a[0:3], v5 offset:24576
    v_mfma_f32_16x16x32_bf16 v[112:115], a[20:23], v[160:163], v[112:115]
    ds_read_b128 a[4:7], v5 offset:25600
    buffer_load_dwordx4 v[240:243], v5, s[44:47], s74 offen offset:0 sc1
    v_mfma_f32_16x16x32_bf16 v[112:115], a[24:27], v[168:171], v[112:115]
    ds_read_b128 a[8:11], v5 offset:26624
    v_mfma_f32_16x16x32_bf16 v[112:115], a[28:31], v[176:179], v[112:115]
    ds_read_b128 a[12:15], v5 offset:27648
    v_mfma_f32_16x16x32_bf16 v[116:119], a[16:19], v[156:159], v[116:119]
    v_mfma_f32_16x16x32_bf16 v[116:119], a[20:23], v[164:167], v[116:119]
    buffer_load_dwordx4 v5, s[24:27], s60 offen offset:2048 sc1 lds
    v_mfma_f32_16x16x32_bf16 v[116:119], a[24:27], v[172:175], v[116:119]
    s_waitcnt vmcnt(12)
    v_mfma_f32_16x16x32_bf16 v[116:119], a[28:31], v[180:183], v[116:119]
    s_waitcnt lgkmcnt(4)
    s_barrier
    v_mfma_f32_16x16x32_bf16 v[120:123], a[32:35], v[152:155], v[120:123]
    ds_read_b128 a[16:19], v3 offset:0
    v_mfma_f32_16x16x32_bf16 v[120:123], a[36:39], v[160:163], v[120:123]
    ds_read_b128 a[20:23], v3 offset:1024
    buffer_load_dwordx4 v[244:247], v5, s[44:47], s74 offen offset:1024 sc1
    v_mfma_f32_16x16x32_bf16 v[120:123], a[40:43], v[168:171], v[120:123]
    ds_read_b128 a[24:27], v3 offset:2048
    v_mfma_f32_16x16x32_bf16 v[120:123], a[44:47], v[176:179], v[120:123]
    ds_read_b128 a[28:31], v3 offset:3072
    v_mfma_f32_16x16x32_bf16 v[124:127], a[32:35], v[156:159], v[124:127]
    s_add_u32 s74, s74, 131072
    v_mfma_f32_16x16x32_bf16 v[124:127], a[36:39], v[164:167], v[124:127]
    buffer_load_dwordx4 v5, s[24:27], s60 offen offset:3072 sc1 lds
    v_mfma_f32_16x16x32_bf16 v[124:127], a[40:43], v[172:175], v[124:127]
    s_add_u32 s60, s60, 4096
    v_mfma_f32_16x16x32_bf16 v[124:127], a[44:47], v[180:183], v[124:127]
    s_waitcnt lgkmcnt(4)
    v_mfma_f32_16x16x32_bf16 v[128:131], a[0:3], v[152:155], v[128:131]
    ds_read_b128 a[32:35], v3 offset:4096
    v_mfma_f32_16x16x32_bf16 v[128:131], a[4:7], v[160:163], v[128:131]
    ds_read_b128 a[36:39], v3 offset:5120
    buffer_load_dwordx4 v[248:251], v5, s[44:47], s74 offen offset:0 sc1
    v_mfma_f32_16x16x32_bf16 v[128:131], a[8:11], v[168:171], v[128:131]
    ds_read_b128 a[40:43], v3 offset:6144
    v_mfma_f32_16x16x32_bf16 v[128:131], a[12:15], v[176:179], v[128:131]
    ds_read_b128 a[44:47], v3 offset:7168
    v_mfma_f32_16x16x32_bf16 v[132:135], a[0:3], v[156:159], v[132:135]
    s_add_u32 m0, s59, 81920
    v_mfma_f32_16x16x32_bf16 v[132:135], a[4:7], v[164:167], v[132:135]
    buffer_load_dwordx4 v5, s[24:27], s60 offen offset:0 sc1 lds
    v_mfma_f32_16x16x32_bf16 v[132:135], a[8:11], v[172:175], v[132:135]
    v_mfma_f32_16x16x32_bf16 v[132:135], a[12:15], v[180:183], v[132:135]
    s_waitcnt lgkmcnt(4)
    v_mfma_f32_16x16x32_bf16 v[80:83], a[16:19], v[184:187], v[80:83]
    ds_read_b128 a[0:3], v3 offset:8192
    v_mfma_f32_16x16x32_bf16 v[80:83], a[20:23], v[192:195], v[80:83]
    ds_read_b128 a[4:7], v3 offset:9216
    buffer_load_dwordx4 v[252:255], v5, s[44:47], s74 offen offset:1024 sc1
    v_mfma_f32_16x16x32_bf16 v[80:83], a[24:27], v[200:203], v[80:83]
    ds_read_b128 a[8:11], v3 offset:10240
    v_mfma_f32_16x16x32_bf16 v[80:83], a[28:31], v[208:211], v[80:83]
    ds_read_b128 a[12:15], v3 offset:11264
    v_mfma_f32_16x16x32_bf16 v[84:87], a[16:19], v[188:191], v[84:87]
    s_add_u32 s30, s12, 16512
    v_mfma_f32_16x16x32_bf16 v[84:87], a[20:23], v[196:199], v[84:87]
    v_mfma_f32_16x16x32_bf16 v[84:87], a[24:27], v[204:207], v[84:87]
    v_mfma_f32_16x16x32_bf16 v[84:87], a[28:31], v[212:215], v[84:87]
    s_waitcnt lgkmcnt(4)
    v_mfma_f32_16x16x32_bf16 v[88:91], a[32:35], v[184:187], v[88:91]
    ds_read_b128 a[16:19], v3 offset:12288
    buffer_load_dwordx2 v[16:17], v6, s[20:23], s12 offen sc1
    v_mfma_f32_16x16x32_bf16 v[88:91], a[36:39], v[192:195], v[88:91]
    ds_read_b128 a[20:23], v3 offset:13312
    s_lshl_b32 s32, s19, 7
    v_mfma_f32_16x16x32_bf16 v[88:91], a[40:43], v[200:203], v[88:91]
    ds_read_b128 a[24:27], v3 offset:14336
    v_mfma_f32_16x16x32_bf16 v[88:91], a[44:47], v[208:211], v[88:91]
    ds_read_b128 a[28:31], v3 offset:15360
    v_mfma_f32_16x16x32_bf16 v[92:95], a[32:35], v[188:191], v[92:95]
    buffer_load_dwordx2 v[18:19], v6, s[20:23], s30 offen sc1
    s_add_u32 s12, s12, s32
    v_mfma_f32_16x16x32_bf16 v[92:95], a[36:39], v[196:199], v[92:95]
    s_add_u32 s30, s30, s32
    v_mfma_f32_16x16x32_bf16 v[92:95], a[40:43], v[204:207], v[92:95]
    s_add_u32 s32, s13, s32
    v_mfma_f32_16x16x32_bf16 v[92:95], a[44:47], v[212:215], v[92:95]
    s_waitcnt lgkmcnt(4)
    v_mfma_f32_16x16x32_bf16 v[96:99], a[0:3], v[184:187], v[96:99]
    ds_read_b128 a[32:35], v3 offset:16384
    v_mfma_f32_16x16x32_bf16 v[96:99], a[4:7], v[192:195], v[96:99]
    ds_read_b128 a[36:39], v3 offset:17408
    buffer_load_dwordx2 v[20:21], v6, s[20:23], s12 offen sc1
    v_mfma_f32_16x16x32_bf16 v[96:99], a[8:11], v[200:203], v[96:99]
    ds_read_b128 a[40:43], v3 offset:18432
    s_mov_b64 s[44:45], s[76:77]
    v_mfma_f32_16x16x32_bf16 v[96:99], a[12:15], v[208:211], v[96:99]
    ds_read_b128 a[44:47], v3 offset:19456
    v_mfma_f32_16x16x32_bf16 v[100:103], a[0:3], v[188:191], v[100:103]
    s_mov_b32 s46, 2359296
    v_mfma_f32_16x16x32_bf16 v[100:103], a[4:7], v[196:199], v[100:103]
    buffer_load_dwordx2 v[22:23], v6, s[20:23], s30 offen sc1
    s_mul_i32 s19, s19, 18432
    v_mfma_f32_16x16x32_bf16 v[100:103], a[8:11], v[204:207], v[100:103]
    s_add_u32 s34, s16, s19
    s_add_u32 s35, s18, s19
    v_mfma_f32_16x16x32_bf16 v[100:103], a[12:15], v[212:215], v[100:103]
    s_waitcnt lgkmcnt(4)
    v_mfma_f32_16x16x32_bf16 v[104:107], a[16:19], v[184:187], v[104:107]
    ds_read_b128 a[0:3], v3 offset:20480
    v_mfma_f32_16x16x32_bf16 v[104:107], a[20:23], v[192:195], v[104:107]
    ds_read_b128 a[4:7], v3 offset:21504
    v_mfma_f32_16x16x32_bf16 v[104:107], a[24:27], v[200:203], v[104:107]
    ds_read_b128 a[8:11], v3 offset:22528
    buffer_load_dwordx4 v[28:31], v8, s[44:47], s16 offen
    v_mfma_f32_16x16x32_bf16 v[104:107], a[28:31], v[208:211], v[104:107]
    ds_read_b128 a[12:15], v3 offset:23552
    s_lshl_b32 s30, s6, 11
    v_mfma_f32_16x16x32_bf16 v[108:111], a[16:19], v[188:191], v[108:111]
    v_add_u32 v56, s30, v5
    v_mfma_f32_16x16x32_bf16 v[108:111], a[20:23], v[196:199], v[108:111]
    v_add_u32 v217, 8192, v217
    v_mfma_f32_16x16x32_bf16 v[108:111], a[24:27], v[204:207], v[108:111]
    s_sub_u32 s62, s62, 1024
    v_mfma_f32_16x16x32_bf16 v[108:111], a[28:31], v[212:215], v[108:111]
    s_waitcnt lgkmcnt(4)
    v_mfma_f32_16x16x32_bf16 v[112:115], a[32:35], v[184:187], v[112:115]
    ds_read_b128 a[16:19], v3 offset:24576
    buffer_load_dwordx4 v[32:35], v8, s[44:47], s34 offen
    v_mfma_f32_16x16x32_bf16 v[112:115], a[36:39], v[192:195], v[112:115]
    ds_read_b128 a[20:23], v3 offset:25600
    v_mfma_f32_16x16x32_bf16 v[112:115], a[40:43], v[200:203], v[112:115]
    ds_read_b128 a[24:27], v3 offset:26624
    v_mfma_f32_16x16x32_bf16 v[112:115], a[44:47], v[208:211], v[112:115]
    ds_read_b128 a[28:31], v3 offset:27648
    v_mfma_f32_16x16x32_bf16 v[116:119], a[32:35], v[188:191], v[116:119]
    s_mul_i32 s33, s8, 27648
    v_mfma_f32_16x16x32_bf16 v[116:119], a[36:39], v[196:199], v[116:119]
    s_sub_u32 s33, s15, s33
    v_mfma_f32_16x16x32_bf16 v[116:119], a[40:43], v[204:207], v[116:119]
    s_waitcnt vmcnt(6)
    v_mfma_f32_16x16x32_bf16 v[116:119], a[44:47], v[212:215], v[116:119]
    s_waitcnt lgkmcnt(4)
    s_barrier
    v_mfma_f32_16x16x32_bf16 v[120:123], a[0:3], v[184:187], v[120:123]
    ds_read_b128 a[32:35], v4 offset:0
    buffer_load_dwordx2 v[24:25], v7, s[20:23], s13 offen sc1
    v_mfma_f32_16x16x32_bf16 v[120:123], a[4:7], v[192:195], v[120:123]
    ds_read_b128 a[36:39], v4 offset:1024
    s_xor_b32 s30, s8, 3
    v_mfma_f32_16x16x32_bf16 v[120:123], a[8:11], v[200:203], v[120:123]
    ds_read_b128 a[40:43], v4 offset:2048
    s_mul_i32 s30, s30, 9216
    v_mfma_f32_16x16x32_bf16 v[120:123], a[12:15], v[208:211], v[120:123]
    ds_read_b128 a[44:47], v4 offset:3072
    s_add_u32 s36, s30, s15
    v_mfma_f32_16x16x32_bf16 v[124:127], a[0:3], v[188:191], v[124:127]
    s_lshl2_add_u32 s56, s30, s33
    v_mfma_f32_16x16x32_bf16 v[124:127], a[4:7], v[196:199], v[124:127]
    buffer_load_dwordx2 v[26:27], v7, s[20:23], s32 offen sc1
    s_xor_b32 s30, s8, 2
    v_mfma_f32_16x16x32_bf16 v[124:127], a[8:11], v[204:207], v[124:127]
    s_mul_i32 s30, s30, 9216
    s_add_u32 s37, s30, s15
    v_mfma_f32_16x16x32_bf16 v[124:127], a[12:15], v[212:215], v[124:127]
    s_waitcnt lgkmcnt(4)
    s_lshl2_add_u32 s57, s30, s33
    v_mfma_f32_16x16x32_bf16 v[128:131], a[16:19], v[184:187], v[128:131]
    ds_read_b128 a[0:3], v4 offset:4096
    v_mfma_f32_16x16x32_bf16 v[128:131], a[20:23], v[192:195], v[128:131]
    ds_read_b128 a[4:7], v4 offset:5120
    v_mfma_f32_16x16x32_bf16 v[128:131], a[24:27], v[200:203], v[128:131]
    ds_read_b128 a[8:11], v4 offset:6144
    buffer_load_dwordx2 v[36:37], v9, s[44:47], s18 offen
    v_mfma_f32_16x16x32_bf16 v[128:131], a[28:31], v[208:211], v[128:131]
    ds_read_b128 a[12:15], v4 offset:7168
    s_xor_b32 s30, s8, 1
    v_mfma_f32_16x16x32_bf16 v[132:135], a[16:19], v[188:191], v[132:135]
    s_mul_i32 s30, s30, 9216
    v_mfma_f32_16x16x32_bf16 v[132:135], a[20:23], v[196:199], v[132:135]
    s_add_u32 s38, s30, s15
    v_mfma_f32_16x16x32_bf16 v[132:135], a[24:27], v[204:207], v[132:135]
    s_lshl2_add_u32 s58, s30, s33
    v_mfma_f32_16x16x32_bf16 v[132:135], a[28:31], v[212:215], v[132:135]
    s_waitcnt lgkmcnt(4)
    buffer_load_dwordx2 v[38:39], v9, s[44:47], s35 offen
    v_mfma_f32_16x16x32_bf16 v[80:83], a[32:35], v[224:227], v[80:83]
    ds_read_b128 a[16:19], v4 offset:8192
    v_mfma_f32_16x16x32_bf16 v[80:83], a[36:39], v[232:235], v[80:83]
    ds_read_b128 a[20:23], v4 offset:9216
    v_mfma_f32_16x16x32_bf16 v[80:83], a[40:43], v[240:243], v[80:83]
    ds_read_b128 a[24:27], v4 offset:10240
    v_mfma_f32_16x16x32_bf16 v[80:83], a[44:47], v[248:251], v[80:83]
    ds_read_b128 a[28:31], v4 offset:11264
    v_mfma_f32_16x16x32_bf16 v[84:87], a[32:35], v[228:231], v[84:87]
    v_mfma_f32_16x16x32_bf16 v[84:87], a[36:39], v[236:239], v[84:87]
    v_mfma_f32_16x16x32_bf16 v[84:87], a[40:43], v[244:247], v[84:87]
    v_mfma_f32_16x16x32_bf16 v[84:87], a[44:47], v[252:255], v[84:87]
    s_waitcnt lgkmcnt(4)
    v_mfma_f32_16x16x32_bf16 v[88:91], a[0:3], v[224:227], v[88:91]
    ds_read_b128 a[32:35], v4 offset:12288
    v_mfma_f32_16x16x32_bf16 v[88:91], a[4:7], v[232:235], v[88:91]
    ds_read_b128 a[36:39], v4 offset:13312
    v_mfma_f32_16x16x32_bf16 v[88:91], a[8:11], v[240:243], v[88:91]
    ds_read_b128 a[40:43], v4 offset:14336
    v_mfma_f32_16x16x32_bf16 v[88:91], a[12:15], v[248:251], v[88:91]
    ds_read_b128 a[44:47], v4 offset:15360
    v_cvt_pk_bf16_f32 v40, v80, v81
    v_mfma_f32_16x16x32_bf16 v[92:95], a[0:3], v[228:231], v[92:95]
    v_cvt_pk_bf16_f32 v41, v82, v83
    v_mfma_f32_16x16x32_bf16 v[92:95], a[4:7], v[236:239], v[92:95]
    v_cvt_pk_bf16_f32 v42, v84, v85
    v_cvt_pk_bf16_f32 v43, v86, v87
    v_mfma_f32_16x16x32_bf16 v[92:95], a[8:11], v[244:247], v[92:95]
    buffer_store_dwordx4 v[40:43], v219, s[20:23], s62 offen offset:0 sc1
    v_mfma_f32_16x16x32_bf16 v[92:95], a[12:15], v[252:255], v[92:95]
    s_waitcnt lgkmcnt(4)
    v_mfma_f32_16x16x32_bf16 v[96:99], a[16:19], v[224:227], v[96:99]
    ds_read_b128 a[0:3], v4 offset:16384
    v_mfma_f32_16x16x32_bf16 v[96:99], a[20:23], v[232:235], v[96:99]
    ds_read_b128 a[4:7], v4 offset:17408
    v_mfma_f32_16x16x32_bf16 v[96:99], a[24:27], v[240:243], v[96:99]
    ds_read_b128 a[8:11], v4 offset:18432
    v_mfma_f32_16x16x32_bf16 v[96:99], a[28:31], v[248:251], v[96:99]
    ds_read_b128 a[12:15], v4 offset:19456
    v_mfma_f32_16x16x32_bf16 v[100:103], a[16:19], v[228:231], v[100:103]
    buffer_store_dword v77, v11, s[20:23], 0 offen sc1
    v_mfma_f32_16x16x32_bf16 v[100:103], a[20:23], v[236:239], v[100:103]
    v_mfma_f32_16x16x32_bf16 v[100:103], a[24:27], v[244:247], v[100:103]
    v_mfma_f32_16x16x32_bf16 v[100:103], a[28:31], v[252:255], v[100:103]
    s_waitcnt lgkmcnt(4)
    v_mfma_f32_16x16x32_bf16 v[104:107], a[32:35], v[224:227], v[104:107]
    ds_read_b128 a[16:19], v4 offset:20480
    v_cvt_pk_bf16_f32 v44, v88, v89
    v_mfma_f32_16x16x32_bf16 v[104:107], a[36:39], v[232:235], v[104:107]
    ds_read_b128 a[20:23], v4 offset:21504
    v_cvt_pk_bf16_f32 v45, v90, v91
    v_mfma_f32_16x16x32_bf16 v[104:107], a[40:43], v[240:243], v[104:107]
    ds_read_b128 a[24:27], v4 offset:22528
    v_cvt_pk_bf16_f32 v46, v96, v97
    v_mfma_f32_16x16x32_bf16 v[104:107], a[44:47], v[248:251], v[104:107]
    ds_read_b128 a[28:31], v4 offset:23552
    v_cvt_pk_bf16_f32 v47, v98, v99
    v_mfma_f32_16x16x32_bf16 v[108:111], a[32:35], v[228:231], v[108:111]
    buffer_store_dwordx4 v[44:47], v56, s[20:23], s56 offen offset:0 sc1
    v_cvt_pk_bf16_f32 v48, v92, v93
    v_mfma_f32_16x16x32_bf16 v[108:111], a[36:39], v[236:239], v[108:111]
    v_cvt_pk_bf16_f32 v49, v94, v95
    v_cvt_pk_bf16_f32 v50, v100, v101
    v_mfma_f32_16x16x32_bf16 v[108:111], a[40:43], v[244:247], v[108:111]
    v_cvt_pk_bf16_f32 v51, v102, v103
    v_mfma_f32_16x16x32_bf16 v[108:111], a[44:47], v[252:255], v[108:111]
    s_waitcnt lgkmcnt(4)
    v_mfma_f32_16x16x32_bf16 v[112:115], a[0:3], v[224:227], v[112:115]
    ds_read_b128 a[32:35], v4 offset:24576
    buffer_store_dwordx4 v[48:51], v56, s[20:23], s56 offen offset:1024 sc1
    v_mfma_f32_16x16x32_bf16 v[112:115], a[4:7], v[232:235], v[112:115]
    ds_read_b128 a[36:39], v4 offset:25600
    v_mfma_f32_16x16x32_bf16 v[112:115], a[8:11], v[240:243], v[112:115]
    ds_read_b128 a[40:43], v4 offset:26624
    v_mfma_f32_16x16x32_bf16 v[112:115], a[12:15], v[248:251], v[112:115]
    ds_read_b128 a[44:47], v4 offset:27648
    v_mfma_f32_16x16x32_bf16 v[116:119], a[0:3], v[228:231], v[116:119]
    buffer_load_dword v76, v216, s[20:23], 0 offen sc1
    v_mfma_f32_16x16x32_bf16 v[116:119], a[4:7], v[236:239], v[116:119]
    v_mfma_f32_16x16x32_bf16 v[116:119], a[8:11], v[244:247], v[116:119]
    v_mfma_f32_16x16x32_bf16 v[116:119], a[12:15], v[252:255], v[116:119]
    s_waitcnt lgkmcnt(4)
    v_mfma_f32_16x16x32_bf16 v[120:123], a[16:19], v[224:227], v[120:123]
    ds_read_b128 a[0:3], v5 offset:28672
    v_cvt_pk_bf16_f32 v44, v104, v105
    v_mfma_f32_16x16x32_bf16 v[120:123], a[20:23], v[232:235], v[120:123]
    ds_read_b128 a[4:7], v5 offset:29696
    v_cvt_pk_bf16_f32 v45, v106, v107
    v_mfma_f32_16x16x32_bf16 v[120:123], a[24:27], v[240:243], v[120:123]
    ds_read_b128 a[8:11], v5 offset:30720
    v_cvt_pk_bf16_f32 v46, v112, v113
    v_mfma_f32_16x16x32_bf16 v[120:123], a[28:31], v[248:251], v[120:123]
    ds_read_b128 a[12:15], v5 offset:31744
    v_cvt_pk_bf16_f32 v47, v114, v115
    v_mfma_f32_16x16x32_bf16 v[124:127], a[16:19], v[228:231], v[124:127]
    buffer_store_dwordx4 v[44:47], v56, s[20:23], s57 offen offset:0 sc1
    v_cvt_pk_bf16_f32 v48, v108, v109
    v_mfma_f32_16x16x32_bf16 v[124:127], a[20:23], v[236:239], v[124:127]
    v_cvt_pk_bf16_f32 v49, v110, v111
    v_cvt_pk_bf16_f32 v50, v116, v117
    v_mfma_f32_16x16x32_bf16 v[124:127], a[24:27], v[244:247], v[124:127]
    v_cvt_pk_bf16_f32 v51, v118, v119
    v_mfma_f32_16x16x32_bf16 v[124:127], a[28:31], v[252:255], v[124:127]
    s_waitcnt lgkmcnt(4)
    v_mfma_f32_16x16x32_bf16 v[128:131], a[32:35], v[224:227], v[128:131]
    ds_read_b128 a[16:19], v5 offset:32768
    buffer_store_dwordx4 v[48:51], v56, s[20:23], s57 offen offset:1024 sc1
    v_mfma_f32_16x16x32_bf16 v[128:131], a[36:39], v[232:235], v[128:131]
    ds_read_b128 a[20:23], v5 offset:33792
    s_waitcnt vmcnt(7)
    v_mfma_f32_16x16x32_bf16 v[128:131], a[40:43], v[240:243], v[128:131]
    ds_read_b128 a[24:27], v5 offset:34816
    s_movk_i32 s30, 0x3f80
    v_mfma_f32_16x16x32_bf16 v[128:131], a[44:47], v[248:251], v[128:131]
    ds_read_b128 a[28:31], v5 offset:35840
    s_mov_b32 s31, 1.0
    v_mfma_f32_16x16x32_bf16 v[132:135], a[32:35], v[228:231], v[132:135]
    v_lshlrev_b32 v88, 16, v28
    v_and_b32 v89, 0xffff0000, v28
    v_mfma_f32_16x16x32_bf16 v[132:135], a[36:39], v[236:239], v[132:135]
    v_lshlrev_b32 v90, 16, v29
    v_and_b32 v91, 0xffff0000, v29
    v_mfma_f32_16x16x32_bf16 v[132:135], a[40:43], v[244:247], v[132:135]
    v_lshlrev_b32 v92, 16, v30
    v_and_b32 v93, 0xffff0000, v30
    v_mfma_f32_16x16x32_bf16 v[132:135], a[44:47], v[252:255], v[132:135]
    s_waitcnt lgkmcnt(4)
    v_lshlrev_b32 v94, 16, v31
    v_mfma_f32_16x16x32_bf16 v[136:139], a[0:3], v[152:155], v[136:139]
    ds_read_b128 a[32:35], v3 offset:28672
    v_cvt_pk_bf16_f32 v44, v120, v121
    v_mfma_f32_16x16x32_bf16 v[136:139], a[4:7], v[160:163], v[136:139]
    ds_read_b128 a[36:39], v3 offset:29696
    v_cvt_pk_bf16_f32 v45, v122, v123
    v_mfma_f32_16x16x32_bf16 v[136:139], a[8:11], v[168:171], v[136:139]
    ds_read_b128 a[40:43], v3 offset:30720
    v_cvt_pk_bf16_f32 v46, v128, v129
    v_mfma_f32_16x16x32_bf16 v[136:139], a[12:15], v[176:179], v[136:139]
    ds_read_b128 a[44:47], v3 offset:31744
    v_cvt_pk_bf16_f32 v47, v130, v131
    v_mfma_f32_16x16x32_bf16 v[140:143], a[0:3], v[156:159], v[140:143]
    buffer_store_dwordx4 v[44:47], v56, s[20:23], s58 offen offset:0 sc1
    v_cvt_pk_bf16_f32 v48, v124, v125
    v_mfma_f32_16x16x32_bf16 v[140:143], a[4:7], v[164:167], v[140:143]
    v_cvt_pk_bf16_f32 v49, v126, v127
    v_cvt_pk_bf16_f32 v50, v132, v133
    v_mfma_f32_16x16x32_bf16 v[140:143], a[8:11], v[172:175], v[140:143]
    v_cvt_pk_bf16_f32 v51, v134, v135
    v_mfma_f32_16x16x32_bf16 v[140:143], a[12:15], v[180:183], v[140:143]
    s_waitcnt lgkmcnt(4)
    s_branch PG_8_go
PG_8_prev_end:
    .p2align 12
PG_8:
    s_setpc_b64 s[82:83]
PG_8_go:
    v_mfma_f32_16x16x32_bf16 v[144:147], a[16:19], v[152:155], v[144:147]
    ds_read_b128 a[0:3], v3 offset:32768
    buffer_store_dwordx4 v[48:51], v56, s[20:23], s58 offen offset:1024 sc1
    v_mfma_f32_16x16x32_bf16 v[144:147], a[20:23], v[160:163], v[144:147]
    ds_read_b128 a[4:7], v3 offset:33792
    v_and_b32 v95, 0xffff0000, v31
    v_mfma_f32_16x16x32_bf16 v[144:147], a[24:27], v[168:171], v[144:147]
    ds_read_b128 a[8:11], v3 offset:34816
    v_lshlrev_b32 v96, 16, v32
    v_mfma_f32_16x16x32_bf16 v[144:147], a[28:31], v[176:179], v[144:147]
    ds_read_b128 a[12:15], v3 offset:35840
    v_and_b32 v97, 0xffff0000, v32
    v_mfma_f32_16x16x32_bf16 v[148:151], a[16:19], v[156:159], v[148:151]
    v_lshlrev_b32 v98, 16, v33
    v_and_b32 v99, 0xffff0000, v33
    v_mfma_f32_16x16x32_bf16 v[148:151], a[20:23], v[164:167], v[148:151]
    v_lshlrev_b32 v100, 16, v34
    v_and_b32 v101, 0xffff0000, v34
    v_mfma_f32_16x16x32_bf16 v[148:151], a[24:27], v[172:175], v[148:151]
    v_lshlrev_b32 v102, 16, v35
    v_and_b32 v103, 0xffff0000, v35
    v_mfma_f32_16x16x32_bf16 v[148:151], a[28:31], v[180:183], v[148:151]
    s_waitcnt lgkmcnt(4)
    v_lshlrev_b32 v104, 16, v36
    v_mfma_f32_16x16x32_bf16 v[136:139], a[32:35], v[184:187], v[136:139]
    ds_read_b128 a[16:19], v4 offset:28672
    v_and_b32 v105, 0xffff0000, v36
    v_mfma_f32_16x16x32_bf16 v[136:139], a[36:39], v[192:195], v[136:139]
    ds_read_b128 a[20:23], v4 offset:29696
    v_lshlrev_b32 v106, 16, v37
    v_mfma_f32_16x16x32_bf16 v[136:139], a[40:43], v[200:203], v[136:139]
    ds_read_b128 a[24:27], v4 offset:30720
    s_waitcnt vmcnt(4)
    v_cmp_gt_i32 vcc, 33, v76
    v_mfma_f32_16x16x32_bf16 v[136:139], a[44:47], v[208:211], v[136:139]
    ds_read_b128 a[28:31], v4 offset:31744
    v_and_b32 v107, 0xffff0000, v37
    v_mfma_f32_16x16x32_bf16 v[140:143], a[32:35], v[188:191], v[140:143]
    s_and_b32 s33, vcc_lo, 7
    v_lshlrev_b32 v108, 16, v38
    v_mfma_f32_16x16x32_bf16 v[140:143], a[36:39], v[196:199], v[140:143]
    s_bitcmp1_b32 s33, 0
    s_cselect_b32 s42, 0, 0x10000000
    v_mfma_f32_16x16x32_bf16 v[140:143], a[40:43], v[204:207], v[140:143]
    buffer_load_dwordx4 v[112:115], v56, s[40:43], s36 offen sc1
    v_and_b32 v109, 0xffff0000, v38
    v_mfma_f32_16x16x32_bf16 v[140:143], a[44:47], v[212:215], v[140:143]
    s_waitcnt lgkmcnt(4)
    v_lshlrev_b32 v110, 16, v39
    v_mfma_f32_16x16x32_bf16 v[144:147], a[0:3], v[184:187], v[144:147]
    ds_read_b128 a[32:35], v4 offset:32768
    v_and_b32 v111, 0xffff0000, v39
    v_mfma_f32_16x16x32_bf16 v[144:147], a[4:7], v[192:195], v[144:147]
    ds_read_b128 a[36:39], v4 offset:33792
    buffer_load_dwordx4 v[116:119], v56, s[40:43], s36 offen offset:1024 sc1
    v_mfma_f32_16x16x32_bf16 v[144:147], a[8:11], v[200:203], v[144:147]
    ds_read_b128 a[40:43], v4 offset:34816
    v_mfma_f32_16x16x32_bf16 v[144:147], a[12:15], v[208:211], v[144:147]
    ds_read_b128 a[44:47], v4 offset:35840
    v_mfma_f32_16x16x32_bf16 v[148:151], a[0:3], v[188:191], v[148:151]
    buffer_load_dwordx4 v[120:123], v217, s[40:43], s36 offen sc1
    v_mfma_f32_16x16x32_bf16 v[148:151], a[4:7], v[196:199], v[148:151]
    v_mfma_f32_16x16x32_bf16 v[148:151], a[8:11], v[204:207], v[148:151]
    s_bitcmp1_b32 s33, 1
    s_cselect_b32 s42, 0, 0x10000000
    v_mfma_f32_16x16x32_bf16 v[148:151], a[12:15], v[212:215], v[148:151]
    s_waitcnt lgkmcnt(4)
    buffer_load_dwordx4 v[124:127], v56, s[40:43], s37 offen sc1
    v_mfma_f32_16x16x32_bf16 v[136:139], a[16:19], v[224:227], v[136:139]
    v_mfma_f32_16x16x32_bf16 v[136:139], a[20:23], v[232:235], v[136:139]
    v_mfma_f32_16x16x32_bf16 v[136:139], a[24:27], v[240:243], v[136:139]
    buffer_load_dwordx4 v[128:131], v56, s[40:43], s37 offen offset:1024 sc1
    v_mfma_f32_16x16x32_bf16 v[136:139], a[28:31], v[248:251], v[136:139]
    v_mfma_f32_16x16x32_bf16 v[140:143], a[16:19], v[228:231], v[140:143]
    v_mfma_f32_16x16x32_bf16 v[140:143], a[20:23], v[236:239], v[140:143]
    buffer_load_dwordx4 v[132:135], v217, s[40:43], s37 offen sc1
    v_mfma_f32_16x16x32_bf16 v[140:143], a[24:27], v[244:247], v[140:143]
    v_mfma_f32_16x16x32_bf16 v[140:143], a[28:31], v[252:255], v[140:143]
    s_waitcnt lgkmcnt(0)
    s_bitcmp1_b32 s33, 2
    s_cselect_b32 s42, 0, 0x10000000
    v_mfma_f32_16x16x32_bf16 v[144:147], a[32:35], v[224:227], v[144:147]
    buffer_load_dwordx4 v[60:63], v56, s[40:43], s38 offen sc1
    v_mfma_f32_16x16x32_bf16 v[144:147], a[36:39], v[232:235], v[144:147]
    v_mfma_f32_16x16x32_bf16 v[144:147], a[40:43], v[240:243], v[144:147]
    v_mfma_f32_16x16x32_bf16 v[144:147], a[44:47], v[248:251], v[144:147]
    buffer_load_dwordx4 v[64:67], v56, s[40:43], s38 offen offset:1024 sc1
    v_mfma_f32_16x16x32_bf16 v[148:151], a[32:35], v[228:231], v[148:151]
    v_mfma_f32_16x16x32_bf16 v[148:151], a[36:39], v[236:239], v[148:151]
    v_mfma_f32_16x16x32_bf16 v[148:151], a[40:43], v[244:247], v[148:151]
    buffer_load_dwordx4 v[68:71], v217, s[40:43], s38 offen sc1
    v_mfma_f32_16x16x32_bf16 v[148:151], a[44:47], v[252:255], v[148:151]
    v_dot2_f32_bf16 v88, v16, s30, v88
    v_dot2_f32_bf16 v89, v16, s31, v89
    v_dot2_f32_bf16 v90, v17, s30, v90
    v_dot2_f32_bf16 v91, v17, s31, v91
    v_dot2_f32_bf16 v92, v18, s30, v92
    v_dot2_f32_bf16 v93, v18, s31, v93
    v_dot2_f32_bf16 v94, v19, s30, v94
    v_dot2_f32_bf16 v95, v19, s31, v95
    v_dot2_f32_bf16 v96, v20, s30, v96
    v_dot2_f32_bf16 v97, v20, s31, v97
    v_dot2_f32_bf16 v98, v21, s30, v98
    v_dot2_f32_bf16 v99, v21, s31, v99
    v_dot2_f32_bf16 v100, v22, s30, v100
    v_dot2_f32_bf16 v101, v22, s31, v101
    v_dot2_f32_bf16 v102, v23, s30, v102
    v_dot2_f32_bf16 v103, v23, s31, v103
    v_dot2_f32_bf16 v104, v24, s30, v104
    v_dot2_f32_bf16 v105, v24, s31, v105
    v_dot2_f32_bf16 v106, v25, s30, v106
    v_dot2_f32_bf16 v107, v25, s31, v107
    v_dot2_f32_bf16 v108, v26, s30, v108
    v_dot2_f32_bf16 v109, v26, s31, v109
    v_dot2_f32_bf16 v110, v27, s30, v110
    v_dot2_f32_bf16 v111, v27, s31, v111
    v_pk_add_f32 v[88:89], v[88:89], v[136:137]
    v_pk_add_f32 v[90:91], v[90:91], v[138:139]
    v_pk_add_f32 v[92:93], v[92:93], v[144:145]
    v_pk_add_f32 v[94:95], v[94:95], v[146:147]
    v_pk_add_f32 v[96:97], v[96:97], v[140:141]
    v_pk_add_f32 v[98:99], v[98:99], v[142:143]
    v_pk_add_f32 v[100:101], v[100:101], v[148:149]
    v_pk_add_f32 v[102:103], v[102:103], v[150:151]
    v_pk_add_f32 v[104:105], v[104:105], v[80:81]
    v_pk_add_f32 v[106:107], v[106:107], v[82:83]
    v_pk_add_f32 v[108:109], v[108:109], v[84:85]
    v_pk_add_f32 v[110:111], v[110:111], v[86:87]
    s_mov_b32 s42, 0x10000000
    s_mov_b32 s39, 65536
    s_cmp_eq_u32 s33, 0
    s_cbranch_scc1 KP_v
    s_mov_b32 s61, 1048576
    s_branch KP_q_f
KP_q:
    s_sleep 1
KP_q_f:
    buffer_load_dword v76, v216, s[20:23], 0 offen sc1
    s_sub_u32 s61, s61, 1
    s_cbranch_scc1 KP_q_x
    s_waitcnt vmcnt(0)
    v_cmp_gt_i32 vcc, 33, v76
    s_cbranch_vccnz KP_q
KP_q_x:
KP_vl:
    s_bitcmp1_b32 s33, 0
    s_cbranch_scc0 KP_vl0
    buffer_load_dwordx4 v[112:115], v56, s[40:43], s36 offen sc1
    buffer_load_dwordx4 v[116:119], v56, s[40:43], s36 offen offset:1024 sc1
    buffer_load_dwordx4 v[120:123], v217, s[40:43], s36 offen sc1
KP_vl0:
    s_bitcmp1_b32 s33, 1
    s_cbranch_scc0 KP_vl1
    buffer_load_dwordx4 v[124:127], v56, s[40:43], s37 offen sc1
    buffer_load_dwordx4 v[128:131], v56, s[40:43], s37 offen offset:1024 sc1
    buffer_load_dwordx4 v[132:135], v217, s[40:43], s37 offen sc1
KP_vl1:
    s_bitcmp1_b32 s33, 2
    s_cbranch_scc0 KP_vl2
    buffer_load_dwordx4 v[60:63], v56, s[40:43], s38 offen sc1
    buffer_load_dwordx4 v[64:67], v56, s[40:43], s38 offen offset:1024 sc1
    buffer_load_dwordx4 v[68:71], v217, s[40:43], s38 offen sc1
KP_vl2:
KP_v:
    s_waitcnt vmcnt(0)
    v_max3_u32 v72, v112, v113, v114
    v_max3_u32 v73, v124, v125, v126
    v_max3_u32 v74, v60, v61, v62
    v_max3_u32 v72, v72, v115, v116
    v_max3_u32 v73, v73, v127, v128
    v_max3_u32 v74, v74, v63, v64
    v_max3_u32 v72, v72, v117, v118
    v_max3_u32 v73, v73, v129, v130
    v_max3_u32 v74, v74, v65, v66
    v_max3_u32 v72, v72, v119, v120
    v_max3_u32 v73, v73, v131, v132
    v_max3_u32 v74, v74, v67, v68
    v_max3_u32 v72, v72, v121, v122
    v_max3_u32 v73, v73, v133, v134
    v_max3_u32 v74, v74, v69, v70
    v_max_u32 v72, v72, v123
    v_max_u32 v73, v73, v135
    v_max_u32 v74, v74, v71
    v_max3_u32 v75, v72, v73, v74
    v_cmp_eq_u32 vcc, -1, v75
    s_cbranch_vccz KP_v_x
    s_mov_b32 s33, 0
    v_cmp_eq_u32 vcc, -1, v72
    s_nop 1
    s_cmp_lg_u64 vcc, 0
    s_cselect_b32 s7, 1, 0
    s_or_b32 s33, s33, s7
    v_cmp_eq_u32 vcc, -1, v73
    s_nop 1
    s_cmp_lg_u64 vcc, 0
    s_cselect_b32 s7, 2, 0
    s_or_b32 s33, s33, s7
    v_cmp_eq_u32 vcc, -1, v74
    s_nop 1
    s_cmp_lg_u64 vcc, 0
    s_cselect_b32 s7, 4, 0
    s_or_b32 s33, s33, s7
    s_sub_u32 s39, s39, 1
    s_cbranch_scc0 KP_vl
KP_v_x:
    v_dot2_f32_bf16 v88, v112, s30, v88
    v_dot2_f32_bf16 v89, v112, s31, v89
    v_dot2_f32_bf16 v90, v113, s30, v90
    v_dot2_f32_bf16 v91, v113, s31, v91
    v_dot2_f32_bf16 v92, v114, s30, v92
    v_dot2_f32_bf16 v93, v114, s31, v93
    v_dot2_f32_bf16 v94, v115, s30, v94
    v_dot2_f32_bf16 v95, v115, s31, v95
    v_dot2_f32_bf16 v88, v124, s30, v88
    v_dot2_f32_bf16 v89, v124, s31, v89
    v_dot2_f32_bf16 v90, v125, s30, v90
    v_dot2_f32_bf16 v91, v125, s31, v91
    v_dot2_f32_bf16 v92, v126, s30, v92
    v_dot2_f32_bf16 v93, v126, s31, v93
    v_dot2_f32_bf16 v94, v127, s30, v94
    v_dot2_f32_bf16 v95, v127, s31, v95
    v_dot2_f32_bf16 v88, v60, s30, v88
    v_dot2_f32_bf16 v89, v60, s31, v89
    v_dot2_f32_bf16 v90, v61, s30, v90
    v_dot2_f32_bf16 v91, v61, s31, v91
    v_dot2_f32_bf16 v92, v62, s30, v92
    v_dot2_f32_bf16 v93, v62, s31, v93
    v_dot2_f32_bf16 v94, v63, s30, v94
    v_dot2_f32_bf16 v95, v63, s31, v95
    v_cvt_pk_bf16_f32 v40, v88, v89
    v_cvt_pk_bf16_f32 v41, v90, v91
    v_cvt_pk_bf16_f32 v42, v92, v93
    v_cvt_pk_bf16_f32 v43, v94, v95
    buffer_store_dwordx4 v[40:43], v8, s[68:71], s16 offen sc1
    v_dot2_f32_bf16 v96, v116, s30, v96
    v_dot2_f32_bf16 v97, v116, s31, v97
    v_dot2_f32_bf16 v98, v117, s30, v98
    v_dot2_f32_bf16 v99, v117, s31, v99
    v_dot2_f32_bf16 v100, v118, s30, v100
    v_dot2_f32_bf16 v101, v118, s31, v101
    v_dot2_f32_bf16 v102, v119, s30, v102
    v_dot2_f32_bf16 v103, v119, s31, v103
    v_dot2_f32_bf16 v96, v128, s30, v96
    v_dot2_f32_bf16 v97, v128, s31, v97
    v_dot2_f32_bf16 v98, v129, s30, v98
    v_dot2_f32_bf16 v99, v129, s31, v99
    v_dot2_f32_bf16 v100, v130, s30, v100
    v_dot2_f32_bf16 v101, v130, s31, v101
    v_dot2_f32_bf16 v102, v131, s30, v102
    v_dot2_f32_bf16 v103, v131, s31, v103
    v_dot2_f32_bf16 v96, v64, s30, v96
    v_dot2_f32_bf16 v97, v64, s31, v97
    v_dot2_f32_bf16 v98, v65, s30, v98
    v_dot2_f32_bf16 v99, v65, s31, v99
    v_dot2_f32_bf16 v100, v66, s30, v100
    v_dot2_f32_bf16 v101, v66, s31, v101
    v_dot2_f32_bf16 v102, v67, s30, v102
    v_dot2_f32_bf16 v103, v67, s31, v103
    v_cvt_pk_bf16_f32 v44, v96, v97
    v_cvt_pk_bf16_f32 v45, v98, v99
    v_cvt_pk_bf16_f32 v46, v100, v101
    v_cvt_pk_bf16_f32 v47, v102, v103
    buffer_store_dwordx4 v[44:47], v8, s[68:71], s34 offen sc1
    s_cmp_lg_u32 s6, s8
    s_cbranch_scc1 KP_fin
    v_dot2_f32_bf16 v104, v120, s30, v104
    v_dot2_f32_bf16 v105, v120, s31, v105
    v_dot2_f32_bf16 v106, v121, s30, v106
    v_dot2_f32_bf16 v107, v121, s31, v107
    v_dot2_f32_bf16 v108, v122, s30, v108
    v_dot2_f32_bf16 v109, v122, s31, v109
    v_dot2_f32_bf16 v110, v123, s30, v110
    v_dot2_f32_bf16 v111, v123, s31, v111
    v_dot2_f32_bf16 v104, v132, s30, v104
    v_dot2_f32_bf16 v105, v132, s31, v105
    v_dot2_f32_bf16 v106, v133, s30, v106
    v_dot2_f32_bf16 v107, v133, s31, v107
    v_dot2_f32_bf16 v108, v134, s30, v108
    v_dot2_f32_bf16 v109, v134, s31, v109
    v_dot2_f32_bf16 v110, v135, s30, v110
    v_dot2_f32_bf16 v111, v135, s31, v111
    v_dot2_f32_bf16 v104, v68, s30, v104
    v_dot2_f32_bf16 v105, v68, s31, v105
    v_dot2_f32_bf16 v106, v69, s30, v106
    v_dot2_f32_bf16 v107, v69, s31, v107
    v_dot2_f32_bf16 v108, v70, s30, v108
    v_dot2_f32_bf16 v109, v70, s31, v109
    v_dot2_f32_bf16 v110, v71, s30, v110
    v_dot2_f32_bf16 v111, v71, s31, v111
    v_cvt_pk_bf16_f32 v48, v104, v105
    v_cvt_pk_bf16_f32 v49, v106, v107
    v_cvt_pk_bf16_f32 v50, v108, v109
    v_cvt_pk_bf16_f32 v51, v110, v111
    buffer_store_dwordx2 v[48:49], v9, s[68:71], s18 offen sc1
    buffer_store_dwordx2 v[50:51], v9, s[68:71], s35 offen sc1
KP_fin:
KP_end:
    s_endpgm
KP_idle:

    s_mov_b32 s50, 0x10000000
    v_mov_b32 v13, v192
    s_mov_b32 s61, 1048576
KP_idd:
    s_sleep 32
KP_idd_f:
    buffer_load_dword v76, v13, s[20:23], 0 offen sc1
    s_sub_u32 s61, s61, 1
    s_cbranch_scc1 KP_idd_x
    s_waitcnt vmcnt(0)
    v_cmp_ne_u32 vcc, 1, v76
    s_cbranch_vccnz KP_idd
KP_idd_x:
    v_mov_b32 v13, v190
    s_mov_b32 s17, 10
KP_idl:
    s_sub_u32 s17, s17, 1
    s_bitcmp1_b32 0x3fe, s17
    s_cselect_b32 s66, 0x10000000, 0
    s_cselect_b32 m0, s57, 0x30000
    s_cselect_b32 s58, 2048, 0
    buffer_load_dwordx4 v5, s[64:67], s56 offen offset:0 sc1 lds
    buffer_load_dwordx4 v5, s[64:67], s56 offen offset:1024 sc1 lds
    s_add_u32 s56, s56, s58
    s_add_u32 s57, s57, s58
    buffer_store_dwordx4 v[220:223], v219, s[64:67], s62 offen sc1
    s_lshr_b32 s58, s58, 1
    s_add_u32 s62, s62, s58
    s_cmp_lg_u32 s17, 0
    s_cbranch_scc1 KP_idl
    v_mov_b64 v[80:81], 0
    v_mov_b64 v[82:83], 0
    v_mov_b64 v[84:85], 0
    v_mov_b64 v[86:87], 0
    v_mov_b64 v[88:89], 0
    v_mov_b64 v[90:91], 0
    v_mov_b64 v[92:93], 0
    v_mov_b64 v[94:95], 0
    v_mov_b64 v[96:97], 0
    v_mov_b64 v[98:99], 0
    v_mov_b64 v[100:101], 0
    v_mov_b64 v[102:103], 0
    v_mov_b64 v[104:105], 0
    v_mov_b64 v[106:107], 0
    v_mov_b64 v[108:109], 0
    v_mov_b64 v[110:111], 0
    v_mov_b64 v[112:113], 0
    v_mov_b64 v[114:115], 0
    v_mov_b64 v[116:117], 0
    v_mov_b64 v[118:119], 0
    v_mov_b64 v[120:121], 0
    v_mov_b64 v[122:123], 0
    v_mov_b64 v[124:125], 0
    v_mov_b64 v[126:127], 0
    v_mov_b64 v[128:129], 0
    v_mov_b64 v[130:131], 0
    v_mov_b64 v[132:133], 0
    v_mov_b64 v[134:135], 0
    v_mov_b64 v[136:137], 0
    v_mov_b64 v[138:139], 0
    v_mov_b64 v[140:141], 0
    v_mov_b64 v[142:143], 0
    v_mov_b64 v[144:145], 0
    v_mov_b64 v[146:147], 0
    v_mov_b64 v[148:149], 0
    v_mov_b64 v[150:151], 0
    s_mov_b32 s61, 1048576
KP_idw:
    s_sleep 32
KP_idw_f:
    buffer_load_dword v76, v13, s[20:23], 0 offen sc1
    s_sub_u32 s61, s61, 1
    s_cbranch_scc1 KP_idw_x
    s_waitcnt vmcnt(0)
    v_cmp_lt_i32 vcc, v76, v15
    s_cbranch_vccnz KP_idw
KP_idw_x:
    buffer_load_dwordx4 v[152:155], v5, s[44:47], s74 offen offset:0 sc1
    buffer_load_dwordx4 v[156:159], v5, s[44:47], s74 offen offset:1024 sc1
    s_add_u32 s74, s74, 131072
    buffer_load_dwordx4 v[160:163], v5, s[44:47], s74 offen offset:0 sc1
    buffer_load_dwordx4 v[164:167], v5, s[44:47], s74 offen offset:1024 sc1
    s_add_u32 s74, s74, 131072
    buffer_load_dwordx4 v[168:171], v5, s[44:47], s74 offen offset:0 sc1
    buffer_load_dwordx4 v[172:175], v5, s[44:47], s74 offen offset:1024 sc1
    s_add_u32 s74, s74, 131072
    buffer_load_dwordx4 v[176:179], v5, s[44:47], s74 offen offset:0 sc1
    buffer_load_dwordx4 v[180:183], v5, s[44:47], s74 offen offset:1024 sc1
    s_add_u32 s74, s74, 655360
    s_cmp_ge_u32 s74, s75
    s_cselect_b32 s30, 4718592, 0
    s_sub_u32 s74, s74, s30
    buffer_load_dwordx4 v[184:187], v5, s[44:47], s74 offen offset:0 sc1
    buffer_load_dwordx4 v[188:191], v5, s[44:47], s74 offen offset:1024 sc1
    s_add_u32 s74, s74, 131072
    buffer_load_dwordx4 v[192:195], v5, s[44:47], s74 offen offset:0 sc1
    buffer_load_dwordx4 v[196:199], v5, s[44:47], s74 offen offset:1024 sc1
    s_add_u32 s74, s74, 131072
    buffer_load_dwordx4 v[200:203], v5, s[44:47], s74 offen offset:0 sc1
    buffer_load_dwordx4 v[204:207], v5, s[44:47], s74 offen offset:1024 sc1
    s_add_u32 s74, s74, 131072
    buffer_load_dwordx4 v[208:211], v5, s[44:47], s74 offen offset:0 sc1
    buffer_load_dwordx4 v[212:215], v5, s[44:47], s74 offen offset:1024 sc1
    s_add_u32 s74, s74, 655360
    s_cmp_ge_u32 s74, s75
    s_cselect_b32 s30, 4718592, 0
    s_sub_u32 s74, s74, s30
    s_waitcnt vmcnt(0) lgkmcnt(0)
    s_barrier
    ds_read_b128 a[0:3], v5 offset:0
    ds_read_b128 a[4:7], v5 offset:1024
    ds_read_b128 a[8:11], v5 offset:2048
    ds_read_b128 a[12:15], v5 offset:3072
    ds_read_b128 a[16:19], v5 offset:4096
    ds_read_b128 a[20:23], v5 offset:5120
    ds_read_b128 a[24:27], v5 offset:6144
    ds_read_b128 a[28:31], v5 offset:7168
    s_add_u32 m0, s59, 73728
    s_nop 0
    buffer_load_dwordx4 v5, s[24:27], s60 offen offset:0 sc1 lds
    buffer_load_dwordx4 v5, s[24:27], s60 offen offset:1024 sc1 lds
    v_mov_b32 v77, 32
    s_branch PG_6_go
PG_X_prev_end:
    .p2align 12

.section .rodata,"a"
.p2align 6
.amdhsa_kernel sequential_preLN__ssm_conv_s4__glu_gated_bilinear__prompt_kernel
  .amdhsa_next_free_vgpr 512
  .amdhsa_next_free_sgpr 102
  .amdhsa_accum_offset 256
  .amdhsa_group_segment_fixed_size 0
  .amdhsa_kernarg_size 128
  .amdhsa_user_sgpr_count 2
  .amdhsa_user_sgpr_kernarg_segment_ptr 1
  .amdhsa_system_sgpr_workgroup_id_x 1
  .amdhsa_float_denorm_mode_32 3
.end_amdhsa_kernel
```
